```python
import torch

def _softmax(x, axis=-1):
    return torch.softmax(x, dim=axis)
def _gelu(x):
    return torch.nn.functional.gelu(x, approximate="tanh")
def _silu(x):
    return torch.nn.functional.silu(x)
def _sigmoid(x):
    return torch.sigmoid(x)
def _layernorm(x, axis=-1, eps=1e-5):
    m = x.mean(dim=axis, keepdim=True)
    v = x.var(dim=axis, keepdim=True, unbiased=False)
    return (x - m) / torch.sqrt(v + eps)
def _scatter_add(tgt, idx, src, axis=0):
    return tgt.clone().index_add_(axis, idx, src)
def _segment_sum(src, seg, n):
    out = torch.zeros((n,) + src.shape[1:], dtype=src.dtype)
    return out.index_add_(0, seg, src)
def _pad(x, pw):
    flat = tuple(v for pair in reversed(pw) for v in pair)
    return torch.nn.functional.pad(x, flat)

kernel_name = 'gated_mix__sliding_block__swiglu_ffn__prompt'

def setup_inputs():

    _w = (lambda a: (lambda t: t.to(torch.bfloat16) if t.is_floating_point() else t)(torch.as_tensor(a)))
    def _A_setup():
        B, S, D = 1, 2048, 640
        return {
            "x": _w((lambda *s: torch.randn(*s, dtype=torch.bfloat16) * 0.05)(B, S, D)),
            "wqkv": _w((lambda *s: torch.randn(*s, dtype=torch.bfloat16) * 1.6)(D, 3 * D)),
            "wo": _w((lambda *s: torch.randn(*s, dtype=torch.bfloat16) * 0.05)(D, D)),
        }
    _A_in = _A_setup()

    def _B_setup():
        B, S, D, F = 1, 2048, 640, 1728
        return {
            "x": _w((lambda *s: torch.randn(*s, dtype=torch.bfloat16) * 0.05)(B, S, D)),
            "w_gate": _w((lambda *s: torch.randn(*s, dtype=torch.bfloat16) * 0.4)(D, F)),
            "w_up": _w((lambda *s: torch.randn(*s, dtype=torch.bfloat16) * 0.4)(D, F)),
            "w_down": _w((lambda *s: torch.randn(*s, dtype=torch.bfloat16) * 0.4)(F, D)),
        }
    _B_in = _B_setup()

    return {
        "A_x": _A_in["x"],
        "A_wqkv": _A_in["wqkv"],
        "A_wo": _A_in["wo"],
        "B_x": _B_in["x"],
        "B_w_gate": _B_in["w_gate"],
        "B_w_up": _B_in["w_up"],
        "B_w_down": _B_in["w_down"],
        "gate_w": _w((lambda *s: torch.randn(*s, dtype=torch.bfloat16) * 0.05)(640) * 16.0),
    }

def reference(A_x, A_wqkv, A_wo, B_x, B_w_gate, B_w_up, B_w_down, gate_w):
    def _A_ref(x, wqkv, wo):
        B, S, D = x.shape
        H = 32; Dh = D // H; W = 256
        qkv = (lambda x, *d: x.permute(*d))((x @ wqkv).reshape(B, S, 3, H, Dh), 2, 0, 3, 1, 4)
        q, k, v = qkv[0], qkv[1], qkv[2]
        scores = torch.einsum("bhqd,bhkd->bhqk", q, k) * (Dh ** -0.5)
        idx = torch.arange(S)
        mask = (idx[:, None] - idx[None, :] >= 0) & (idx[:, None] - idx[None, :] < W)
        scores = torch.where(mask[None, None], scores, -1e9)
        p = _softmax(scores, axis=-1)
        o = torch.einsum("bhqk,bhkd->bhqd", p, v)
        return (lambda x, *d: x.permute(*d))(o, 0, 2, 1, 3).reshape(B, S, D) @ wo

    def _B_ref(x, w_gate, w_up, w_down):
        g = _silu(x @ w_gate)
        u = x @ w_up
        return (g * u) @ w_down

    x = A_x
    g = _sigmoid((x * gate_w).sum(-1, keepdims=True))
    a = _A_ref(x, A_wqkv, A_wo)
    b = _B_ref(x, B_w_gate, B_w_up, B_w_down)
    return g * a + (1 - g) * b
```

```asm
; @launch kernel=k1_kernel grid=(256,1,1) block=(512,1,1) lds=131072
; @launch kernel=k2_kernel grid=(512,1,1) block=(256,1,1) lds=0
; @launch kernel=k3_kernel grid=(256,1,1) block=(256,1,1) lds=122880
.amdgcn_target "amdgcn-amd-amdhsa--gfx950"
.text
.globl k1_kernel
.p2align 8
.type k1_kernel,@function
k1_kernel:
    s_cmp_ge_u32 s2, 224
    s_cbranch_scc1 k1_kernel_gate
    s_load_dwordx4 s[4:7], s[0:1], 0
    s_load_dwordx4 s[8:11], s[0:1], 32
    s_load_dwordx2 s[12:13], s[0:1], 80
    v_and_b32 v1, 63, v0
    v_lshrrev_b32 v20, 6, v0
    s_and_b32 s28, s2, 7
    s_mul_i32 s28, s28, 28
    s_lshr_b32 s29, s2, 3
    s_add_u32 s29, s29, s28
    s_and_b32 s28, s29, 15
    s_lshr_b32 s29, s29, 4
    v_readfirstlane_b32 s30, v20
    s_nop 3
    s_lshr_b32 s31, s30, 1
    s_and_b32 s32, s30, 1
    s_waitcnt lgkmcnt(0)
    s_mov_b32 s16, s4
    s_and_b32 s17, s5, 0xffff
    s_mov_b32 s18, 2621440
    s_mov_b32 s19, 0x00020000
    s_mov_b32 s24, s12
    s_and_b32 s25, s13, 0xffff
    s_mov_b32 s26, 25165824
    s_mov_b32 s27, 0x00020000
    s_mov_b32 s23, 0x00020000
    s_cmp_ge_u32 s29, 5
    s_cbranch_scc1 k1_kernel_ffn_setup
    s_mov_b32 s20, s6
    s_and_b32 s21, s7, 0xffff
    s_mov_b32 s22, 2457600
    s_mov_b32 s33, 3840
    s_mul_i32 s34, s29, 768
    s_cmp_ge_u32 s30, 4
    s_cselect_b32 s41, 384, 0
    s_add_u32 s34, s34, s41
    s_branch k1_kernel_setup_done
    k1_kernel_ffn_setup:
    s_cmp_ge_u32 s30, 4
    s_cselect_b32 s20, s10, s8
    s_cselect_b32 s21, s11, s9
    s_and_b32 s21, s21, 0xffff
    s_mov_b32 s22, 2211840
    s_mov_b32 s33, 3456
    s_sub_u32 s34, s29, 5
    s_mul_i32 s34, s34, 384
    k1_kernel_setup_done:
    v_lshrrev_b32 v20, 4, v1
    v_lshlrev_b32 v20, 1, v20
    v_mov_b32 v21, 0x78
    v_lshrrev_b32 v21, v20, v21
    v_and_b32 v21, 3, v21
    v_and_b32 v22, 3, v1
    v_xor_b32 v21, v21, v22
    v_lshlrev_b32 v21, 4, v21
    s_lshl_b32 s41, s28, 7
    s_lshl_b32 s42, s30, 4
    s_add_u32 s41, s41, s42
    v_lshrrev_b32 v22, 2, v1
    v_add_u32 v22, s41, v22
    s_movk_i32 s42, 1280
    v_mul_lo_u32 v22, v22, s42
    v_add_u32 v2, v22, v21
    v_lshrrev_b32 v20, 3, v1
    v_mul_lo_u32 v20, v20, s33
    v_lshrrev_b32 v21, 4, v1
    v_and_b32 v21, 1, v21
    v_lshlrev_b32 v21, 1, v21
    v_and_b32 v22, 7, v1
    v_xor_b32 v21, v21, v22
    v_lshlrev_b32 v21, 4, v21
    s_and_b32 s42, s30, 3
    s_mul_i32 s42, s42, 3
    s_lshr_b32 s45, s30, 2
    s_mul_i32 s45, s45, 3
    s_add_u32 s43, s42, 0
    s_lshr_b32 s44, s43, 2
    s_and_b32 s43, s43, 3
    s_and_b32 s46, s43, 1
    s_lshl_b32 s46, s46, 6
    v_xor_b32 v22, s46, v21
    v_add_u32 v22, v22, v20
    s_lshl_b32 s46, s43, 3
    s_mul_i32 s46, s46, s33
    s_lshl_b32 s47, s44, 7
    s_add_u32 s46, s46, s47
    s_add_u32 s46, s46, s34
    v_add_u32 v3, s46, v22
    s_add_u32 s44, s44, s45
    s_lshl_b32 s44, s44, 12
    s_lshl_b32 s43, s43, 10
    s_add_u32 s44, s44, s43
    s_add_u32 s38, s44, 8192
    s_add_u32 s43, s42, 1
    s_lshr_b32 s44, s43, 2
    s_and_b32 s43, s43, 3
    s_and_b32 s46, s43, 1
    s_lshl_b32 s46, s46, 6
    v_xor_b32 v22, s46, v21
    v_add_u32 v22, v22, v20
    s_lshl_b32 s46, s43, 3
    s_mul_i32 s46, s46, s33
    s_lshl_b32 s47, s44, 7
    s_add_u32 s46, s46, s47
    s_add_u32 s46, s46, s34
    v_add_u32 v4, s46, v22
    s_add_u32 s44, s44, s45
    s_lshl_b32 s44, s44, 12
    s_lshl_b32 s43, s43, 10
    s_add_u32 s44, s44, s43
    s_add_u32 s39, s44, 8192
    s_add_u32 s43, s42, 2
    s_lshr_b32 s44, s43, 2
    s_and_b32 s43, s43, 3
    s_and_b32 s46, s43, 1
    s_lshl_b32 s46, s46, 6
    v_xor_b32 v22, s46, v21
    v_add_u32 v22, v22, v20
    s_lshl_b32 s46, s43, 3
    s_mul_i32 s46, s46, s33
    s_lshl_b32 s47, s44, 7
    s_add_u32 s46, s46, s47
    s_add_u32 s46, s46, s34
    v_add_u32 v5, s46, v22
    s_add_u32 s44, s44, s45
    s_lshl_b32 s44, s44, 12
    s_lshl_b32 s43, s43, 10
    s_add_u32 s44, s44, s43
    s_add_u32 s40, s44, 8192
    s_lshl_b32 s37, s30, 10
    v_and_b32 v20, 15, v1
    v_lshrrev_b32 v21, 2, v20
    v_lshlrev_b32 v21, 1, v21
    v_mov_b32 v22, 0x78
    v_lshrrev_b32 v22, v21, v22
    v_and_b32 v22, 3, v22
    v_lshrrev_b32 v23, 4, v1
    v_xor_b32 v22, v22, v23
    v_lshlrev_b32 v22, 4, v22
    s_lshl_b32 s41, s32, 6
    v_add_u32 v20, s41, v20
    v_lshlrev_b32 v20, 6, v20
    v_add_u32 v6, v20, v22
    v_add_u32 v7, 0x10000, v6
    v_lshrrev_b32 v20, 4, v1
    v_bfe_u32 v21, v1, 2, 2
    v_lshlrev_b32 v22, 3, v20
    v_add_u32 v22, v22, v21
    v_lshlrev_b32 v22, 7, v22
    v_and_b32 v23, 1, v1
    v_lshlrev_b32 v23, 3, v23
    v_add_u32 v22, v22, v23
    v_add_u32 v22, 8192, v22
    v_lshrrev_b32 v23, 1, v21
    v_lshlrev_b32 v23, 1, v23
    v_and_b32 v24, 1, v20
    v_lshlrev_b32 v24, 2, v24
    v_or_b32 v23, v23, v24
    v_bfe_u32 v24, v1, 1, 1
    v_xor_b32 v23, v23, v24
    s_mul_i32 s41, s31, 3
    s_add_u32 s42, s41, 0
    s_lshr_b32 s43, s42, 2
    s_and_b32 s42, s42, 3
    s_lshl_b32 s42, s42, 1
    s_lshl_b32 s43, s43, 12
    v_xor_b32 v24, s42, v23
    v_lshlrev_b32 v24, 4, v24
    v_add_u32 v24, v24, v22
    v_add_u32 v8, s43, v24
    v_add_u32 v14, 0x10000, v8
    s_add_u32 s42, s41, 1
    s_lshr_b32 s43, s42, 2
    s_and_b32 s42, s42, 3
    s_lshl_b32 s42, s42, 1
    s_lshl_b32 s43, s43, 12
    v_xor_b32 v24, s42, v23
    v_lshlrev_b32 v24, 4, v24
    v_add_u32 v24, v24, v22
    v_add_u32 v9, s43, v24
    v_add_u32 v15, 0x10000, v9
    s_add_u32 s42, s41, 2
    s_lshr_b32 s43, s42, 2
    s_and_b32 s42, s42, 3
    s_lshl_b32 s42, s42, 1
    s_lshl_b32 s43, s43, 12
    v_xor_b32 v24, s42, v23
    v_lshlrev_b32 v24, 4, v24
    v_add_u32 v24, v24, v22
    v_add_u32 v10, s43, v24
    v_add_u32 v16, 0x10000, v10
    s_add_u32 s42, s41, 12
    s_lshr_b32 s43, s42, 2
    s_and_b32 s42, s42, 3
    s_lshl_b32 s42, s42, 1
    s_lshl_b32 s43, s43, 12
    v_xor_b32 v24, s42, v23
    v_lshlrev_b32 v24, 4, v24
    v_add_u32 v24, v24, v22
    v_add_u32 v11, s43, v24
    v_add_u32 v17, 0x10000, v11
    s_add_u32 s42, s41, 13
    s_lshr_b32 s43, s42, 2
    s_and_b32 s42, s42, 3
    s_lshl_b32 s42, s42, 1
    s_lshl_b32 s43, s43, 12
    v_xor_b32 v24, s42, v23
    v_lshlrev_b32 v24, 4, v24
    v_add_u32 v24, v24, v22
    v_add_u32 v12, s43, v24
    v_add_u32 v18, 0x10000, v12
    s_add_u32 s42, s41, 14
    s_lshr_b32 s43, s42, 2
    s_and_b32 s42, s42, 3
    s_lshl_b32 s42, s42, 1
    s_lshl_b32 s43, s43, 12
    v_xor_b32 v24, s42, v23
    v_lshlrev_b32 v24, 4, v24
    v_add_u32 v24, v24, v22
    v_add_u32 v13, s43, v24
    v_add_u32 v19, 0x10000, v13
    s_mov_b32 s35, 0
    s_mov_b32 s36, 0
    s_lshl_b32 s47, s33, 5
    s_add_u32 m0, s37, 0
    s_nop 0
    buffer_load_dwordx4 v2, s[16:19], s35 offen lds
    s_add_u32 m0, s38, 0
    s_add_u32 s35, s35, 64
    buffer_load_dwordx4 v3, s[20:23], s36 offen lds
    s_add_u32 m0, s39, 0
    s_nop 0
    buffer_load_dwordx4 v4, s[20:23], s36 offen lds
    s_add_u32 m0, s40, 0
    s_nop 0
    buffer_load_dwordx4 v5, s[20:23], s36 offen lds
    s_add_u32 s36, s36, s47
    s_add_u32 m0, s37, 32768
    s_nop 0
    buffer_load_dwordx4 v2, s[16:19], s35 offen lds
    s_add_u32 m0, s38, 32768
    s_add_u32 s35, s35, 64
    buffer_load_dwordx4 v3, s[20:23], s36 offen lds
    s_add_u32 m0, s39, 32768
    s_nop 0
    buffer_load_dwordx4 v4, s[20:23], s36 offen lds
    s_add_u32 m0, s40, 32768
    s_nop 0
    buffer_load_dwordx4 v5, s[20:23], s36 offen lds
    s_add_u32 s36, s36, s47
    s_add_u32 m0, s37, 65536
    s_nop 0
    buffer_load_dwordx4 v2, s[16:19], s35 offen lds
    s_add_u32 m0, s38, 65536
    s_add_u32 s35, s35, 64
    buffer_load_dwordx4 v3, s[20:23], s36 offen lds
    s_add_u32 m0, s39, 65536
    s_nop 0
    buffer_load_dwordx4 v4, s[20:23], s36 offen lds
    s_add_u32 m0, s40, 65536
    s_nop 0
    buffer_load_dwordx4 v5, s[20:23], s36 offen lds
    s_add_u32 s36, s36, s47
    s_add_u32 m0, s37, 98304
    s_nop 0
    buffer_load_dwordx4 v2, s[16:19], s35 offen lds
    s_add_u32 m0, s38, 98304
    s_add_u32 s35, s35, 64
    buffer_load_dwordx4 v3, s[20:23], s36 offen lds
    s_add_u32 m0, s39, 98304
    s_nop 0
    buffer_load_dwordx4 v4, s[20:23], s36 offen lds
    s_add_u32 m0, s40, 98304
    s_nop 0
    buffer_load_dwordx4 v5, s[20:23], s36 offen lds
    s_add_u32 s36, s36, s47
    s_waitcnt vmcnt(12)
    s_barrier
    ds_read_b64_tr_b16 v[144:145], v8 offset:0
    ds_read_b64_tr_b16 v[146:147], v8 offset:512
    ds_read_b128 v[128:131], v6 offset:0
    ds_read_b128 v[132:135], v6 offset:1024
    ds_read_b128 v[136:139], v6 offset:2048
    ds_read_b128 v[140:143], v6 offset:3072
    ds_read_b64_tr_b16 v[148:149], v9 offset:0
    ds_read_b64_tr_b16 v[150:151], v9 offset:512
    ds_read_b64_tr_b16 v[152:153], v10 offset:0
    ds_read_b64_tr_b16 v[154:155], v10 offset:512
    ds_read_b64_tr_b16 v[156:157], v11 offset:0
    ds_read_b64_tr_b16 v[158:159], v11 offset:512
    ds_read_b64_tr_b16 v[160:161], v12 offset:0
    ds_read_b64_tr_b16 v[162:163], v12 offset:512
    ds_read_b64_tr_b16 v[164:165], v13 offset:0
    ds_read_b64_tr_b16 v[166:167], v13 offset:512
    s_waitcnt vmcnt(8) lgkmcnt(0)
    s_barrier
    s_add_u32 m0, s37, 0
    s_nop 0
    buffer_load_dwordx4 v2, s[16:19], s35 offen lds
    s_add_u32 m0, s38, 0
    s_add_u32 s35, s35, 64
    buffer_load_dwordx4 v3, s[20:23], s36 offen lds
    s_add_u32 m0, s39, 0
    s_nop 0
    buffer_load_dwordx4 v4, s[20:23], s36 offen lds
    s_add_u32 m0, s40, 0
    s_nop 0
    buffer_load_dwordx4 v5, s[20:23], s36 offen lds
    s_add_u32 s36, s36, s47
    v_mfma_f32_16x16x32_bf16 v[32:35], v[144:147], v[128:131], 0
    ds_read_b64_tr_b16 v[184:185], v8 offset:32768
    v_mfma_f32_16x16x32_bf16 v[36:39], v[144:147], v[132:135], 0
    ds_read_b64_tr_b16 v[186:187], v8 offset:33280
    v_mfma_f32_16x16x32_bf16 v[40:43], v[144:147], v[136:139], 0
    v_mfma_f32_16x16x32_bf16 v[44:47], v[144:147], v[140:143], 0
    ds_read_b128 v[168:171], v6 offset:32768
    v_mfma_f32_16x16x32_bf16 v[48:51], v[148:151], v[128:131], 0
    ds_read_b128 v[172:175], v6 offset:33792
    v_mfma_f32_16x16x32_bf16 v[52:55], v[148:151], v[132:135], 0
    v_mfma_f32_16x16x32_bf16 v[56:59], v[148:151], v[136:139], 0
    ds_read_b128 v[176:179], v6 offset:34816
    v_mfma_f32_16x16x32_bf16 v[60:63], v[148:151], v[140:143], 0
    ds_read_b128 v[180:183], v6 offset:35840
    v_mfma_f32_16x16x32_bf16 v[64:67], v[152:155], v[128:131], 0
    v_mfma_f32_16x16x32_bf16 v[68:71], v[152:155], v[132:135], 0
    ds_read_b64_tr_b16 v[188:189], v9 offset:32768
    v_mfma_f32_16x16x32_bf16 v[72:75], v[152:155], v[136:139], 0
    ds_read_b64_tr_b16 v[190:191], v9 offset:33280
    v_mfma_f32_16x16x32_bf16 v[76:79], v[152:155], v[140:143], 0
    v_mfma_f32_16x16x32_bf16 v[80:83], v[156:159], v[128:131], 0
    ds_read_b64_tr_b16 v[192:193], v10 offset:32768
    v_mfma_f32_16x16x32_bf16 v[84:87], v[156:159], v[132:135], 0
    ds_read_b64_tr_b16 v[194:195], v10 offset:33280
    v_mfma_f32_16x16x32_bf16 v[88:91], v[156:159], v[136:139], 0
    v_mfma_f32_16x16x32_bf16 v[92:95], v[156:159], v[140:143], 0
    ds_read_b64_tr_b16 v[196:197], v11 offset:32768
    v_mfma_f32_16x16x32_bf16 v[96:99], v[160:163], v[128:131], 0
    ds_read_b64_tr_b16 v[198:199], v11 offset:33280
    v_mfma_f32_16x16x32_bf16 v[100:103], v[160:163], v[132:135], 0
    v_mfma_f32_16x16x32_bf16 v[104:107], v[160:163], v[136:139], 0
    ds_read_b64_tr_b16 v[200:201], v12 offset:32768
    v_mfma_f32_16x16x32_bf16 v[108:111], v[160:163], v[140:143], 0
    ds_read_b64_tr_b16 v[202:203], v12 offset:33280
    v_mfma_f32_16x16x32_bf16 v[112:115], v[164:167], v[128:131], 0
    v_mfma_f32_16x16x32_bf16 v[116:119], v[164:167], v[132:135], 0
    ds_read_b64_tr_b16 v[204:205], v13 offset:32768
    v_mfma_f32_16x16x32_bf16 v[120:123], v[164:167], v[136:139], 0
    ds_read_b64_tr_b16 v[206:207], v13 offset:33280
    v_mfma_f32_16x16x32_bf16 v[124:127], v[164:167], v[140:143], 0
    s_waitcnt vmcnt(8) lgkmcnt(0)
    s_barrier
    s_add_u32 m0, s37, 32768
    s_nop 0
    buffer_load_dwordx4 v2, s[16:19], s35 offen lds
    s_add_u32 m0, s38, 32768
    s_add_u32 s35, s35, 64
    buffer_load_dwordx4 v3, s[20:23], s36 offen lds
    s_add_u32 m0, s39, 32768
    s_nop 0
    buffer_load_dwordx4 v4, s[20:23], s36 offen lds
    s_add_u32 m0, s40, 32768
    s_nop 0
    buffer_load_dwordx4 v5, s[20:23], s36 offen lds
    s_add_u32 s36, s36, s47
    v_mfma_f32_16x16x32_bf16 v[32:35], v[184:187], v[168:171], v[32:35]
    ds_read_b64_tr_b16 v[144:145], v14 offset:0
    v_mfma_f32_16x16x32_bf16 v[36:39], v[184:187], v[172:175], v[36:39]
    ds_read_b64_tr_b16 v[146:147], v14 offset:512
    v_mfma_f32_16x16x32_bf16 v[40:43], v[184:187], v[176:179], v[40:43]
    v_mfma_f32_16x16x32_bf16 v[44:47], v[184:187], v[180:183], v[44:47]
    ds_read_b128 v[128:131], v7 offset:0
    v_mfma_f32_16x16x32_bf16 v[48:51], v[188:191], v[168:171], v[48:51]
    ds_read_b128 v[132:135], v7 offset:1024
    v_mfma_f32_16x16x32_bf16 v[52:55], v[188:191], v[172:175], v[52:55]
    v_mfma_f32_16x16x32_bf16 v[56:59], v[188:191], v[176:179], v[56:59]
    ds_read_b128 v[136:139], v7 offset:2048
    v_mfma_f32_16x16x32_bf16 v[60:63], v[188:191], v[180:183], v[60:63]
    ds_read_b128 v[140:143], v7 offset:3072
    v_mfma_f32_16x16x32_bf16 v[64:67], v[192:195], v[168:171], v[64:67]
    v_mfma_f32_16x16x32_bf16 v[68:71], v[192:195], v[172:175], v[68:71]
    ds_read_b64_tr_b16 v[148:149], v15 offset:0
    v_mfma_f32_16x16x32_bf16 v[72:75], v[192:195], v[176:179], v[72:75]
    ds_read_b64_tr_b16 v[150:151], v15 offset:512
    v_mfma_f32_16x16x32_bf16 v[76:79], v[192:195], v[180:183], v[76:79]
    v_mfma_f32_16x16x32_bf16 v[80:83], v[196:199], v[168:171], v[80:83]
    ds_read_b64_tr_b16 v[152:153], v16 offset:0
    v_mfma_f32_16x16x32_bf16 v[84:87], v[196:199], v[172:175], v[84:87]
    ds_read_b64_tr_b16 v[154:155], v16 offset:512
    v_mfma_f32_16x16x32_bf16 v[88:91], v[196:199], v[176:179], v[88:91]
    v_mfma_f32_16x16x32_bf16 v[92:95], v[196:199], v[180:183], v[92:95]
    ds_read_b64_tr_b16 v[156:157], v17 offset:0
    v_mfma_f32_16x16x32_bf16 v[96:99], v[200:203], v[168:171], v[96:99]
    ds_read_b64_tr_b16 v[158:159], v17 offset:512
    v_mfma_f32_16x16x32_bf16 v[100:103], v[200:203], v[172:175], v[100:103]
    v_mfma_f32_16x16x32_bf16 v[104:107], v[200:203], v[176:179], v[104:107]
    ds_read_b64_tr_b16 v[160:161], v18 offset:0
    v_mfma_f32_16x16x32_bf16 v[108:111], v[200:203], v[180:183], v[108:111]
    ds_read_b64_tr_b16 v[162:163], v18 offset:512
    v_mfma_f32_16x16x32_bf16 v[112:115], v[204:207], v[168:171], v[112:115]
    v_mfma_f32_16x16x32_bf16 v[116:119], v[204:207], v[172:175], v[116:119]
    ds_read_b64_tr_b16 v[164:165], v19 offset:0
    v_mfma_f32_16x16x32_bf16 v[120:123], v[204:207], v[176:179], v[120:123]
    ds_read_b64_tr_b16 v[166:167], v19 offset:512
    v_mfma_f32_16x16x32_bf16 v[124:127], v[204:207], v[180:183], v[124:127]
    s_waitcnt vmcnt(8) lgkmcnt(0)
    s_barrier
    s_add_u32 m0, s37, 65536
    s_nop 0
    buffer_load_dwordx4 v2, s[16:19], s35 offen lds
    s_add_u32 m0, s38, 65536
    s_add_u32 s35, s35, 64
    buffer_load_dwordx4 v3, s[20:23], s36 offen lds
    s_add_u32 m0, s39, 65536
    s_nop 0
    buffer_load_dwordx4 v4, s[20:23], s36 offen lds
    s_add_u32 m0, s40, 65536
    s_nop 0
    buffer_load_dwordx4 v5, s[20:23], s36 offen lds
    s_add_u32 s36, s36, s47
    v_mfma_f32_16x16x32_bf16 v[32:35], v[144:147], v[128:131], v[32:35]
    ds_read_b64_tr_b16 v[184:185], v14 offset:32768
    v_mfma_f32_16x16x32_bf16 v[36:39], v[144:147], v[132:135], v[36:39]
    ds_read_b64_tr_b16 v[186:187], v14 offset:33280
    v_mfma_f32_16x16x32_bf16 v[40:43], v[144:147], v[136:139], v[40:43]
    v_mfma_f32_16x16x32_bf16 v[44:47], v[144:147], v[140:143], v[44:47]
    ds_read_b128 v[168:171], v7 offset:32768
    v_mfma_f32_16x16x32_bf16 v[48:51], v[148:151], v[128:131], v[48:51]
    ds_read_b128 v[172:175], v7 offset:33792
    v_mfma_f32_16x16x32_bf16 v[52:55], v[148:151], v[132:135], v[52:55]
    v_mfma_f32_16x16x32_bf16 v[56:59], v[148:151], v[136:139], v[56:59]
    ds_read_b128 v[176:179], v7 offset:34816
    v_mfma_f32_16x16x32_bf16 v[60:63], v[148:151], v[140:143], v[60:63]
    ds_read_b128 v[180:183], v7 offset:35840
    v_mfma_f32_16x16x32_bf16 v[64:67], v[152:155], v[128:131], v[64:67]
    v_mfma_f32_16x16x32_bf16 v[68:71], v[152:155], v[132:135], v[68:71]
    ds_read_b64_tr_b16 v[188:189], v15 offset:32768
    v_mfma_f32_16x16x32_bf16 v[72:75], v[152:155], v[136:139], v[72:75]
    ds_read_b64_tr_b16 v[190:191], v15 offset:33280
    v_mfma_f32_16x16x32_bf16 v[76:79], v[152:155], v[140:143], v[76:79]
    v_mfma_f32_16x16x32_bf16 v[80:83], v[156:159], v[128:131], v[80:83]
    ds_read_b64_tr_b16 v[192:193], v16 offset:32768
    v_mfma_f32_16x16x32_bf16 v[84:87], v[156:159], v[132:135], v[84:87]
    ds_read_b64_tr_b16 v[194:195], v16 offset:33280
    v_mfma_f32_16x16x32_bf16 v[88:91], v[156:159], v[136:139], v[88:91]
    v_mfma_f32_16x16x32_bf16 v[92:95], v[156:159], v[140:143], v[92:95]
    ds_read_b64_tr_b16 v[196:197], v17 offset:32768
    v_mfma_f32_16x16x32_bf16 v[96:99], v[160:163], v[128:131], v[96:99]
    ds_read_b64_tr_b16 v[198:199], v17 offset:33280
    v_mfma_f32_16x16x32_bf16 v[100:103], v[160:163], v[132:135], v[100:103]
    v_mfma_f32_16x16x32_bf16 v[104:107], v[160:163], v[136:139], v[104:107]
    ds_read_b64_tr_b16 v[200:201], v18 offset:32768
    v_mfma_f32_16x16x32_bf16 v[108:111], v[160:163], v[140:143], v[108:111]
    ds_read_b64_tr_b16 v[202:203], v18 offset:33280
    v_mfma_f32_16x16x32_bf16 v[112:115], v[164:167], v[128:131], v[112:115]
    v_mfma_f32_16x16x32_bf16 v[116:119], v[164:167], v[132:135], v[116:119]
    ds_read_b64_tr_b16 v[204:205], v19 offset:32768
    v_mfma_f32_16x16x32_bf16 v[120:123], v[164:167], v[136:139], v[120:123]
    ds_read_b64_tr_b16 v[206:207], v19 offset:33280
    v_mfma_f32_16x16x32_bf16 v[124:127], v[164:167], v[140:143], v[124:127]
    s_waitcnt vmcnt(8) lgkmcnt(0)
    s_barrier
    s_add_u32 m0, s37, 98304
    s_nop 0
    buffer_load_dwordx4 v2, s[16:19], s35 offen lds
    s_add_u32 m0, s38, 98304
    s_add_u32 s35, s35, 64
    buffer_load_dwordx4 v3, s[20:23], s36 offen lds
    s_add_u32 m0, s39, 98304
    s_nop 0
    buffer_load_dwordx4 v4, s[20:23], s36 offen lds
    s_add_u32 m0, s40, 98304
    s_nop 0
    buffer_load_dwordx4 v5, s[20:23], s36 offen lds
    s_add_u32 s36, s36, s47
    v_mfma_f32_16x16x32_bf16 v[32:35], v[184:187], v[168:171], v[32:35]
    ds_read_b64_tr_b16 v[144:145], v8 offset:0
    v_mfma_f32_16x16x32_bf16 v[36:39], v[184:187], v[172:175], v[36:39]
    ds_read_b64_tr_b16 v[146:147], v8 offset:512
    v_mfma_f32_16x16x32_bf16 v[40:43], v[184:187], v[176:179], v[40:43]
    v_mfma_f32_16x16x32_bf16 v[44:47], v[184:187], v[180:183], v[44:47]
    ds_read_b128 v[128:131], v6 offset:0
    v_mfma_f32_16x16x32_bf16 v[48:51], v[188:191], v[168:171], v[48:51]
    ds_read_b128 v[132:135], v6 offset:1024
    v_mfma_f32_16x16x32_bf16 v[52:55], v[188:191], v[172:175], v[52:55]
    v_mfma_f32_16x16x32_bf16 v[56:59], v[188:191], v[176:179], v[56:59]
    ds_read_b128 v[136:139], v6 offset:2048
    v_mfma_f32_16x16x32_bf16 v[60:63], v[188:191], v[180:183], v[60:63]
    ds_read_b128 v[140:143], v6 offset:3072
    v_mfma_f32_16x16x32_bf16 v[64:67], v[192:195], v[168:171], v[64:67]
    v_mfma_f32_16x16x32_bf16 v[68:71], v[192:195], v[172:175], v[68:71]
    ds_read_b64_tr_b16 v[148:149], v9 offset:0
    v_mfma_f32_16x16x32_bf16 v[72:75], v[192:195], v[176:179], v[72:75]
    ds_read_b64_tr_b16 v[150:151], v9 offset:512
    v_mfma_f32_16x16x32_bf16 v[76:79], v[192:195], v[180:183], v[76:79]
    v_mfma_f32_16x16x32_bf16 v[80:83], v[196:199], v[168:171], v[80:83]
    ds_read_b64_tr_b16 v[152:153], v10 offset:0
    v_mfma_f32_16x16x32_bf16 v[84:87], v[196:199], v[172:175], v[84:87]
    ds_read_b64_tr_b16 v[154:155], v10 offset:512
    v_mfma_f32_16x16x32_bf16 v[88:91], v[196:199], v[176:179], v[88:91]
    v_mfma_f32_16x16x32_bf16 v[92:95], v[196:199], v[180:183], v[92:95]
    ds_read_b64_tr_b16 v[156:157], v11 offset:0
    v_mfma_f32_16x16x32_bf16 v[96:99], v[200:203], v[168:171], v[96:99]
    ds_read_b64_tr_b16 v[158:159], v11 offset:512
    v_mfma_f32_16x16x32_bf16 v[100:103], v[200:203], v[172:175], v[100:103]
    v_mfma_f32_16x16x32_bf16 v[104:107], v[200:203], v[176:179], v[104:107]
    ds_read_b64_tr_b16 v[160:161], v12 offset:0
    v_mfma_f32_16x16x32_bf16 v[108:111], v[200:203], v[180:183], v[108:111]
    ds_read_b64_tr_b16 v[162:163], v12 offset:512
    v_mfma_f32_16x16x32_bf16 v[112:115], v[204:207], v[168:171], v[112:115]
    v_mfma_f32_16x16x32_bf16 v[116:119], v[204:207], v[172:175], v[116:119]
    ds_read_b64_tr_b16 v[164:165], v13 offset:0
    v_mfma_f32_16x16x32_bf16 v[120:123], v[204:207], v[176:179], v[120:123]
    ds_read_b64_tr_b16 v[166:167], v13 offset:512
    v_mfma_f32_16x16x32_bf16 v[124:127], v[204:207], v[180:183], v[124:127]
    s_waitcnt vmcnt(8) lgkmcnt(0)
    s_barrier
    s_add_u32 m0, s37, 0
    s_nop 0
    buffer_load_dwordx4 v2, s[16:19], s35 offen lds
    s_add_u32 m0, s38, 0
    s_add_u32 s35, s35, 64
    buffer_load_dwordx4 v3, s[20:23], s36 offen lds
    s_add_u32 m0, s39, 0
    s_nop 0
    buffer_load_dwordx4 v4, s[20:23], s36 offen lds
    s_add_u32 m0, s40, 0
    s_nop 0
    buffer_load_dwordx4 v5, s[20:23], s36 offen lds
    s_add_u32 s36, s36, s47
    v_mfma_f32_16x16x32_bf16 v[32:35], v[144:147], v[128:131], v[32:35]
    ds_read_b64_tr_b16 v[184:185], v8 offset:32768
    v_mfma_f32_16x16x32_bf16 v[36:39], v[144:147], v[132:135], v[36:39]
    ds_read_b64_tr_b16 v[186:187], v8 offset:33280
    v_mfma_f32_16x16x32_bf16 v[40:43], v[144:147], v[136:139], v[40:43]
    v_mfma_f32_16x16x32_bf16 v[44:47], v[144:147], v[140:143], v[44:47]
    ds_read_b128 v[168:171], v6 offset:32768
    v_mfma_f32_16x16x32_bf16 v[48:51], v[148:151], v[128:131], v[48:51]
    ds_read_b128 v[172:175], v6 offset:33792
    v_mfma_f32_16x16x32_bf16 v[52:55], v[148:151], v[132:135], v[52:55]
    v_mfma_f32_16x16x32_bf16 v[56:59], v[148:151], v[136:139], v[56:59]
    ds_read_b128 v[176:179], v6 offset:34816
    v_mfma_f32_16x16x32_bf16 v[60:63], v[148:151], v[140:143], v[60:63]
    ds_read_b128 v[180:183], v6 offset:35840
    v_mfma_f32_16x16x32_bf16 v[64:67], v[152:155], v[128:131], v[64:67]
    v_mfma_f32_16x16x32_bf16 v[68:71], v[152:155], v[132:135], v[68:71]
    ds_read_b64_tr_b16 v[188:189], v9 offset:32768
    v_mfma_f32_16x16x32_bf16 v[72:75], v[152:155], v[136:139], v[72:75]
    ds_read_b64_tr_b16 v[190:191], v9 offset:33280
    v_mfma_f32_16x16x32_bf16 v[76:79], v[152:155], v[140:143], v[76:79]
    v_mfma_f32_16x16x32_bf16 v[80:83], v[156:159], v[128:131], v[80:83]
    ds_read_b64_tr_b16 v[192:193], v10 offset:32768
    v_mfma_f32_16x16x32_bf16 v[84:87], v[156:159], v[132:135], v[84:87]
    ds_read_b64_tr_b16 v[194:195], v10 offset:33280
    v_mfma_f32_16x16x32_bf16 v[88:91], v[156:159], v[136:139], v[88:91]
    v_mfma_f32_16x16x32_bf16 v[92:95], v[156:159], v[140:143], v[92:95]
    ds_read_b64_tr_b16 v[196:197], v11 offset:32768
    v_mfma_f32_16x16x32_bf16 v[96:99], v[160:163], v[128:131], v[96:99]
    ds_read_b64_tr_b16 v[198:199], v11 offset:33280
    v_mfma_f32_16x16x32_bf16 v[100:103], v[160:163], v[132:135], v[100:103]
    v_mfma_f32_16x16x32_bf16 v[104:107], v[160:163], v[136:139], v[104:107]
    ds_read_b64_tr_b16 v[200:201], v12 offset:32768
    v_mfma_f32_16x16x32_bf16 v[108:111], v[160:163], v[140:143], v[108:111]
    ds_read_b64_tr_b16 v[202:203], v12 offset:33280
    v_mfma_f32_16x16x32_bf16 v[112:115], v[164:167], v[128:131], v[112:115]
    v_mfma_f32_16x16x32_bf16 v[116:119], v[164:167], v[132:135], v[116:119]
    ds_read_b64_tr_b16 v[204:205], v13 offset:32768
    v_mfma_f32_16x16x32_bf16 v[120:123], v[164:167], v[136:139], v[120:123]
    ds_read_b64_tr_b16 v[206:207], v13 offset:33280
    v_mfma_f32_16x16x32_bf16 v[124:127], v[164:167], v[140:143], v[124:127]
    s_waitcnt vmcnt(8) lgkmcnt(0)
    s_barrier
    s_add_u32 m0, s37, 32768
    s_nop 0
    buffer_load_dwordx4 v2, s[16:19], s35 offen lds
    s_add_u32 m0, s38, 32768
    s_add_u32 s35, s35, 64
    buffer_load_dwordx4 v3, s[20:23], s36 offen lds
    s_add_u32 m0, s39, 32768
    s_nop 0
    buffer_load_dwordx4 v4, s[20:23], s36 offen lds
    s_add_u32 m0, s40, 32768
    s_nop 0
    buffer_load_dwordx4 v5, s[20:23], s36 offen lds
    s_add_u32 s36, s36, s47
    v_mfma_f32_16x16x32_bf16 v[32:35], v[184:187], v[168:171], v[32:35]
    ds_read_b64_tr_b16 v[144:145], v14 offset:0
    v_mfma_f32_16x16x32_bf16 v[36:39], v[184:187], v[172:175], v[36:39]
    ds_read_b64_tr_b16 v[146:147], v14 offset:512
    v_mfma_f32_16x16x32_bf16 v[40:43], v[184:187], v[176:179], v[40:43]
    v_mfma_f32_16x16x32_bf16 v[44:47], v[184:187], v[180:183], v[44:47]
    ds_read_b128 v[128:131], v7 offset:0
    v_mfma_f32_16x16x32_bf16 v[48:51], v[188:191], v[168:171], v[48:51]
    ds_read_b128 v[132:135], v7 offset:1024
    v_mfma_f32_16x16x32_bf16 v[52:55], v[188:191], v[172:175], v[52:55]
    v_mfma_f32_16x16x32_bf16 v[56:59], v[188:191], v[176:179], v[56:59]
    ds_read_b128 v[136:139], v7 offset:2048
    v_mfma_f32_16x16x32_bf16 v[60:63], v[188:191], v[180:183], v[60:63]
    ds_read_b128 v[140:143], v7 offset:3072
    v_mfma_f32_16x16x32_bf16 v[64:67], v[192:195], v[168:171], v[64:67]
    v_mfma_f32_16x16x32_bf16 v[68:71], v[192:195], v[172:175], v[68:71]
    ds_read_b64_tr_b16 v[148:149], v15 offset:0
    v_mfma_f32_16x16x32_bf16 v[72:75], v[192:195], v[176:179], v[72:75]
    ds_read_b64_tr_b16 v[150:151], v15 offset:512
    v_mfma_f32_16x16x32_bf16 v[76:79], v[192:195], v[180:183], v[76:79]
    v_mfma_f32_16x16x32_bf16 v[80:83], v[196:199], v[168:171], v[80:83]
    ds_read_b64_tr_b16 v[152:153], v16 offset:0
    v_mfma_f32_16x16x32_bf16 v[84:87], v[196:199], v[172:175], v[84:87]
    ds_read_b64_tr_b16 v[154:155], v16 offset:512
    v_mfma_f32_16x16x32_bf16 v[88:91], v[196:199], v[176:179], v[88:91]
    v_mfma_f32_16x16x32_bf16 v[92:95], v[196:199], v[180:183], v[92:95]
    ds_read_b64_tr_b16 v[156:157], v17 offset:0
    v_mfma_f32_16x16x32_bf16 v[96:99], v[200:203], v[168:171], v[96:99]
    ds_read_b64_tr_b16 v[158:159], v17 offset:512
    v_mfma_f32_16x16x32_bf16 v[100:103], v[200:203], v[172:175], v[100:103]
    v_mfma_f32_16x16x32_bf16 v[104:107], v[200:203], v[176:179], v[104:107]
    ds_read_b64_tr_b16 v[160:161], v18 offset:0
    v_mfma_f32_16x16x32_bf16 v[108:111], v[200:203], v[180:183], v[108:111]
    ds_read_b64_tr_b16 v[162:163], v18 offset:512
    v_mfma_f32_16x16x32_bf16 v[112:115], v[204:207], v[168:171], v[112:115]
    v_mfma_f32_16x16x32_bf16 v[116:119], v[204:207], v[172:175], v[116:119]
    ds_read_b64_tr_b16 v[164:165], v19 offset:0
    v_mfma_f32_16x16x32_bf16 v[120:123], v[204:207], v[176:179], v[120:123]
    ds_read_b64_tr_b16 v[166:167], v19 offset:512
    v_mfma_f32_16x16x32_bf16 v[124:127], v[204:207], v[180:183], v[124:127]
    s_waitcnt vmcnt(8) lgkmcnt(0)
    s_barrier
    s_add_u32 m0, s37, 65536
    s_nop 0
    buffer_load_dwordx4 v2, s[16:19], s35 offen lds
    s_add_u32 m0, s38, 65536
    s_add_u32 s35, s35, 64
    buffer_load_dwordx4 v3, s[20:23], s36 offen lds
    s_add_u32 m0, s39, 65536
    s_nop 0
    buffer_load_dwordx4 v4, s[20:23], s36 offen lds
    s_add_u32 m0, s40, 65536
    s_nop 0
    buffer_load_dwordx4 v5, s[20:23], s36 offen lds
    s_add_u32 s36, s36, s47
    v_mfma_f32_16x16x32_bf16 v[32:35], v[144:147], v[128:131], v[32:35]
    ds_read_b64_tr_b16 v[184:185], v14 offset:32768
    v_mfma_f32_16x16x32_bf16 v[36:39], v[144:147], v[132:135], v[36:39]
    ds_read_b64_tr_b16 v[186:187], v14 offset:33280
    v_mfma_f32_16x16x32_bf16 v[40:43], v[144:147], v[136:139], v[40:43]
    v_mfma_f32_16x16x32_bf16 v[44:47], v[144:147], v[140:143], v[44:47]
    ds_read_b128 v[168:171], v7 offset:32768
    v_mfma_f32_16x16x32_bf16 v[48:51], v[148:151], v[128:131], v[48:51]
    ds_read_b128 v[172:175], v7 offset:33792
    v_mfma_f32_16x16x32_bf16 v[52:55], v[148:151], v[132:135], v[52:55]
    v_mfma_f32_16x16x32_bf16 v[56:59], v[148:151], v[136:139], v[56:59]
    ds_read_b128 v[176:179], v7 offset:34816
    v_mfma_f32_16x16x32_bf16 v[60:63], v[148:151], v[140:143], v[60:63]
    ds_read_b128 v[180:183], v7 offset:35840
    v_mfma_f32_16x16x32_bf16 v[64:67], v[152:155], v[128:131], v[64:67]
    v_mfma_f32_16x16x32_bf16 v[68:71], v[152:155], v[132:135], v[68:71]
    ds_read_b64_tr_b16 v[188:189], v15 offset:32768
    v_mfma_f32_16x16x32_bf16 v[72:75], v[152:155], v[136:139], v[72:75]
    ds_read_b64_tr_b16 v[190:191], v15 offset:33280
    v_mfma_f32_16x16x32_bf16 v[76:79], v[152:155], v[140:143], v[76:79]
    v_mfma_f32_16x16x32_bf16 v[80:83], v[156:159], v[128:131], v[80:83]
    ds_read_b64_tr_b16 v[192:193], v16 offset:32768
    v_mfma_f32_16x16x32_bf16 v[84:87], v[156:159], v[132:135], v[84:87]
    ds_read_b64_tr_b16 v[194:195], v16 offset:33280
    v_mfma_f32_16x16x32_bf16 v[88:91], v[156:159], v[136:139], v[88:91]
    v_mfma_f32_16x16x32_bf16 v[92:95], v[156:159], v[140:143], v[92:95]
    ds_read_b64_tr_b16 v[196:197], v17 offset:32768
    v_mfma_f32_16x16x32_bf16 v[96:99], v[160:163], v[128:131], v[96:99]
    ds_read_b64_tr_b16 v[198:199], v17 offset:33280
    v_mfma_f32_16x16x32_bf16 v[100:103], v[160:163], v[132:135], v[100:103]
    v_mfma_f32_16x16x32_bf16 v[104:107], v[160:163], v[136:139], v[104:107]
    ds_read_b64_tr_b16 v[200:201], v18 offset:32768
    v_mfma_f32_16x16x32_bf16 v[108:111], v[160:163], v[140:143], v[108:111]
    ds_read_b64_tr_b16 v[202:203], v18 offset:33280
    v_mfma_f32_16x16x32_bf16 v[112:115], v[164:167], v[128:131], v[112:115]
    v_mfma_f32_16x16x32_bf16 v[116:119], v[164:167], v[132:135], v[116:119]
    ds_read_b64_tr_b16 v[204:205], v19 offset:32768
    v_mfma_f32_16x16x32_bf16 v[120:123], v[164:167], v[136:139], v[120:123]
    ds_read_b64_tr_b16 v[206:207], v19 offset:33280
    v_mfma_f32_16x16x32_bf16 v[124:127], v[164:167], v[140:143], v[124:127]
    s_waitcnt vmcnt(8) lgkmcnt(0)
    s_barrier
    s_add_u32 m0, s37, 98304
    s_nop 0
    buffer_load_dwordx4 v2, s[16:19], s35 offen lds
    s_add_u32 m0, s38, 98304
    s_add_u32 s35, s35, 64
    buffer_load_dwordx4 v3, s[20:23], s36 offen lds
    s_add_u32 m0, s39, 98304
    s_nop 0
    buffer_load_dwordx4 v4, s[20:23], s36 offen lds
    s_add_u32 m0, s40, 98304
    s_nop 0
    buffer_load_dwordx4 v5, s[20:23], s36 offen lds
    s_add_u32 s36, s36, s47
    v_mfma_f32_16x16x32_bf16 v[32:35], v[184:187], v[168:171], v[32:35]
    ds_read_b64_tr_b16 v[144:145], v8 offset:0
    v_mfma_f32_16x16x32_bf16 v[36:39], v[184:187], v[172:175], v[36:39]
    ds_read_b64_tr_b16 v[146:147], v8 offset:512
    v_mfma_f32_16x16x32_bf16 v[40:43], v[184:187], v[176:179], v[40:43]
    v_mfma_f32_16x16x32_bf16 v[44:47], v[184:187], v[180:183], v[44:47]
    ds_read_b128 v[128:131], v6 offset:0
    v_mfma_f32_16x16x32_bf16 v[48:51], v[188:191], v[168:171], v[48:51]
    ds_read_b128 v[132:135], v6 offset:1024
    v_mfma_f32_16x16x32_bf16 v[52:55], v[188:191], v[172:175], v[52:55]
    v_mfma_f32_16x16x32_bf16 v[56:59], v[188:191], v[176:179], v[56:59]
    ds_read_b128 v[136:139], v6 offset:2048
    v_mfma_f32_16x16x32_bf16 v[60:63], v[188:191], v[180:183], v[60:63]
    ds_read_b128 v[140:143], v6 offset:3072
    v_mfma_f32_16x16x32_bf16 v[64:67], v[192:195], v[168:171], v[64:67]
    v_mfma_f32_16x16x32_bf16 v[68:71], v[192:195], v[172:175], v[68:71]
    ds_read_b64_tr_b16 v[148:149], v9 offset:0
    v_mfma_f32_16x16x32_bf16 v[72:75], v[192:195], v[176:179], v[72:75]
    ds_read_b64_tr_b16 v[150:151], v9 offset:512
    v_mfma_f32_16x16x32_bf16 v[76:79], v[192:195], v[180:183], v[76:79]
    v_mfma_f32_16x16x32_bf16 v[80:83], v[196:199], v[168:171], v[80:83]
    ds_read_b64_tr_b16 v[152:153], v10 offset:0
    v_mfma_f32_16x16x32_bf16 v[84:87], v[196:199], v[172:175], v[84:87]
    ds_read_b64_tr_b16 v[154:155], v10 offset:512
    v_mfma_f32_16x16x32_bf16 v[88:91], v[196:199], v[176:179], v[88:91]
    v_mfma_f32_16x16x32_bf16 v[92:95], v[196:199], v[180:183], v[92:95]
    ds_read_b64_tr_b16 v[156:157], v11 offset:0
    v_mfma_f32_16x16x32_bf16 v[96:99], v[200:203], v[168:171], v[96:99]
    ds_read_b64_tr_b16 v[158:159], v11 offset:512
    v_mfma_f32_16x16x32_bf16 v[100:103], v[200:203], v[172:175], v[100:103]
    v_mfma_f32_16x16x32_bf16 v[104:107], v[200:203], v[176:179], v[104:107]
    ds_read_b64_tr_b16 v[160:161], v12 offset:0
    v_mfma_f32_16x16x32_bf16 v[108:111], v[200:203], v[180:183], v[108:111]
    ds_read_b64_tr_b16 v[162:163], v12 offset:512
    v_mfma_f32_16x16x32_bf16 v[112:115], v[204:207], v[168:171], v[112:115]
    v_mfma_f32_16x16x32_bf16 v[116:119], v[204:207], v[172:175], v[116:119]
    ds_read_b64_tr_b16 v[164:165], v13 offset:0
    v_mfma_f32_16x16x32_bf16 v[120:123], v[204:207], v[176:179], v[120:123]
    ds_read_b64_tr_b16 v[166:167], v13 offset:512
    v_mfma_f32_16x16x32_bf16 v[124:127], v[204:207], v[180:183], v[124:127]
    s_waitcnt vmcnt(8) lgkmcnt(0)
    s_barrier
    s_add_u32 m0, s37, 0
    s_nop 0
    buffer_load_dwordx4 v2, s[16:19], s35 offen lds
    s_add_u32 m0, s38, 0
    s_add_u32 s35, s35, 64
    buffer_load_dwordx4 v3, s[20:23], s36 offen lds
    s_add_u32 m0, s39, 0
    s_nop 0
    buffer_load_dwordx4 v4, s[20:23], s36 offen lds
    s_add_u32 m0, s40, 0
    s_nop 0
    buffer_load_dwordx4 v5, s[20:23], s36 offen lds
    s_add_u32 s36, s36, s47
    v_mfma_f32_16x16x32_bf16 v[32:35], v[144:147], v[128:131], v[32:35]
    ds_read_b64_tr_b16 v[184:185], v8 offset:32768
    v_mfma_f32_16x16x32_bf16 v[36:39], v[144:147], v[132:135], v[36:39]
    ds_read_b64_tr_b16 v[186:187], v8 offset:33280
    v_mfma_f32_16x16x32_bf16 v[40:43], v[144:147], v[136:139], v[40:43]
    v_mfma_f32_16x16x32_bf16 v[44:47], v[144:147], v[140:143], v[44:47]
    ds_read_b128 v[168:171], v6 offset:32768
    v_mfma_f32_16x16x32_bf16 v[48:51], v[148:151], v[128:131], v[48:51]
    ds_read_b128 v[172:175], v6 offset:33792
    v_mfma_f32_16x16x32_bf16 v[52:55], v[148:151], v[132:135], v[52:55]
    v_mfma_f32_16x16x32_bf16 v[56:59], v[148:151], v[136:139], v[56:59]
    ds_read_b128 v[176:179], v6 offset:34816
    v_mfma_f32_16x16x32_bf16 v[60:63], v[148:151], v[140:143], v[60:63]
    ds_read_b128 v[180:183], v6 offset:35840
    v_mfma_f32_16x16x32_bf16 v[64:67], v[152:155], v[128:131], v[64:67]
    v_mfma_f32_16x16x32_bf16 v[68:71], v[152:155], v[132:135], v[68:71]
    ds_read_b64_tr_b16 v[188:189], v9 offset:32768
    v_mfma_f32_16x16x32_bf16 v[72:75], v[152:155], v[136:139], v[72:75]
    ds_read_b64_tr_b16 v[190:191], v9 offset:33280
    v_mfma_f32_16x16x32_bf16 v[76:79], v[152:155], v[140:143], v[76:79]
    v_mfma_f32_16x16x32_bf16 v[80:83], v[156:159], v[128:131], v[80:83]
    ds_read_b64_tr_b16 v[192:193], v10 offset:32768
    v_mfma_f32_16x16x32_bf16 v[84:87], v[156:159], v[132:135], v[84:87]
    ds_read_b64_tr_b16 v[194:195], v10 offset:33280
    v_mfma_f32_16x16x32_bf16 v[88:91], v[156:159], v[136:139], v[88:91]
    v_mfma_f32_16x16x32_bf16 v[92:95], v[156:159], v[140:143], v[92:95]
    ds_read_b64_tr_b16 v[196:197], v11 offset:32768
    v_mfma_f32_16x16x32_bf16 v[96:99], v[160:163], v[128:131], v[96:99]
    ds_read_b64_tr_b16 v[198:199], v11 offset:33280
    v_mfma_f32_16x16x32_bf16 v[100:103], v[160:163], v[132:135], v[100:103]
    v_mfma_f32_16x16x32_bf16 v[104:107], v[160:163], v[136:139], v[104:107]
    ds_read_b64_tr_b16 v[200:201], v12 offset:32768
    v_mfma_f32_16x16x32_bf16 v[108:111], v[160:163], v[140:143], v[108:111]
    ds_read_b64_tr_b16 v[202:203], v12 offset:33280
    v_mfma_f32_16x16x32_bf16 v[112:115], v[164:167], v[128:131], v[112:115]
    v_mfma_f32_16x16x32_bf16 v[116:119], v[164:167], v[132:135], v[116:119]
    ds_read_b64_tr_b16 v[204:205], v13 offset:32768
    v_mfma_f32_16x16x32_bf16 v[120:123], v[164:167], v[136:139], v[120:123]
    ds_read_b64_tr_b16 v[206:207], v13 offset:33280
    v_mfma_f32_16x16x32_bf16 v[124:127], v[164:167], v[140:143], v[124:127]
    s_waitcnt vmcnt(8) lgkmcnt(0)
    s_barrier
    s_add_u32 m0, s37, 32768
    s_nop 0
    buffer_load_dwordx4 v2, s[16:19], s35 offen lds
    s_add_u32 m0, s38, 32768
    s_add_u32 s35, s35, 64
    buffer_load_dwordx4 v3, s[20:23], s36 offen lds
    s_add_u32 m0, s39, 32768
    s_nop 0
    buffer_load_dwordx4 v4, s[20:23], s36 offen lds
    s_add_u32 m0, s40, 32768
    s_nop 0
    buffer_load_dwordx4 v5, s[20:23], s36 offen lds
    s_add_u32 s36, s36, s47
    v_mfma_f32_16x16x32_bf16 v[32:35], v[184:187], v[168:171], v[32:35]
    ds_read_b64_tr_b16 v[144:145], v14 offset:0
    v_mfma_f32_16x16x32_bf16 v[36:39], v[184:187], v[172:175], v[36:39]
    ds_read_b64_tr_b16 v[146:147], v14 offset:512
    v_mfma_f32_16x16x32_bf16 v[40:43], v[184:187], v[176:179], v[40:43]
    v_mfma_f32_16x16x32_bf16 v[44:47], v[184:187], v[180:183], v[44:47]
    ds_read_b128 v[128:131], v7 offset:0
    v_mfma_f32_16x16x32_bf16 v[48:51], v[188:191], v[168:171], v[48:51]
    ds_read_b128 v[132:135], v7 offset:1024
    v_mfma_f32_16x16x32_bf16 v[52:55], v[188:191], v[172:175], v[52:55]
    v_mfma_f32_16x16x32_bf16 v[56:59], v[188:191], v[176:179], v[56:59]
    ds_read_b128 v[136:139], v7 offset:2048
    v_mfma_f32_16x16x32_bf16 v[60:63], v[188:191], v[180:183], v[60:63]
    ds_read_b128 v[140:143], v7 offset:3072
    v_mfma_f32_16x16x32_bf16 v[64:67], v[192:195], v[168:171], v[64:67]
    v_mfma_f32_16x16x32_bf16 v[68:71], v[192:195], v[172:175], v[68:71]
    ds_read_b64_tr_b16 v[148:149], v15 offset:0
    v_mfma_f32_16x16x32_bf16 v[72:75], v[192:195], v[176:179], v[72:75]
    ds_read_b64_tr_b16 v[150:151], v15 offset:512
    v_mfma_f32_16x16x32_bf16 v[76:79], v[192:195], v[180:183], v[76:79]
    v_mfma_f32_16x16x32_bf16 v[80:83], v[196:199], v[168:171], v[80:83]
    ds_read_b64_tr_b16 v[152:153], v16 offset:0
    v_mfma_f32_16x16x32_bf16 v[84:87], v[196:199], v[172:175], v[84:87]
    ds_read_b64_tr_b16 v[154:155], v16 offset:512
    v_mfma_f32_16x16x32_bf16 v[88:91], v[196:199], v[176:179], v[88:91]
    v_mfma_f32_16x16x32_bf16 v[92:95], v[196:199], v[180:183], v[92:95]
    ds_read_b64_tr_b16 v[156:157], v17 offset:0
    v_mfma_f32_16x16x32_bf16 v[96:99], v[200:203], v[168:171], v[96:99]
    ds_read_b64_tr_b16 v[158:159], v17 offset:512
    v_mfma_f32_16x16x32_bf16 v[100:103], v[200:203], v[172:175], v[100:103]
    v_mfma_f32_16x16x32_bf16 v[104:107], v[200:203], v[176:179], v[104:107]
    ds_read_b64_tr_b16 v[160:161], v18 offset:0
    v_mfma_f32_16x16x32_bf16 v[108:111], v[200:203], v[180:183], v[108:111]
    ds_read_b64_tr_b16 v[162:163], v18 offset:512
    v_mfma_f32_16x16x32_bf16 v[112:115], v[204:207], v[168:171], v[112:115]
    v_mfma_f32_16x16x32_bf16 v[116:119], v[204:207], v[172:175], v[116:119]
    ds_read_b64_tr_b16 v[164:165], v19 offset:0
    v_mfma_f32_16x16x32_bf16 v[120:123], v[204:207], v[176:179], v[120:123]
    ds_read_b64_tr_b16 v[166:167], v19 offset:512
    v_mfma_f32_16x16x32_bf16 v[124:127], v[204:207], v[180:183], v[124:127]
    s_waitcnt vmcnt(8) lgkmcnt(0)
    s_barrier
    s_add_u32 m0, s37, 65536
    s_nop 0
    buffer_load_dwordx4 v2, s[16:19], s35 offen lds
    s_add_u32 m0, s38, 65536
    s_add_u32 s35, s35, 64
    buffer_load_dwordx4 v3, s[20:23], s36 offen lds
    s_add_u32 m0, s39, 65536
    s_nop 0
    buffer_load_dwordx4 v4, s[20:23], s36 offen lds
    s_add_u32 m0, s40, 65536
    s_nop 0
    buffer_load_dwordx4 v5, s[20:23], s36 offen lds
    s_add_u32 s36, s36, s47
    v_mfma_f32_16x16x32_bf16 v[32:35], v[144:147], v[128:131], v[32:35]
    ds_read_b64_tr_b16 v[184:185], v14 offset:32768
    v_mfma_f32_16x16x32_bf16 v[36:39], v[144:147], v[132:135], v[36:39]
    ds_read_b64_tr_b16 v[186:187], v14 offset:33280
    v_mfma_f32_16x16x32_bf16 v[40:43], v[144:147], v[136:139], v[40:43]
    v_mfma_f32_16x16x32_bf16 v[44:47], v[144:147], v[140:143], v[44:47]
    ds_read_b128 v[168:171], v7 offset:32768
    v_mfma_f32_16x16x32_bf16 v[48:51], v[148:151], v[128:131], v[48:51]
    ds_read_b128 v[172:175], v7 offset:33792
    v_mfma_f32_16x16x32_bf16 v[52:55], v[148:151], v[132:135], v[52:55]
    v_mfma_f32_16x16x32_bf16 v[56:59], v[148:151], v[136:139], v[56:59]
    ds_read_b128 v[176:179], v7 offset:34816
    v_mfma_f32_16x16x32_bf16 v[60:63], v[148:151], v[140:143], v[60:63]
    ds_read_b128 v[180:183], v7 offset:35840
    v_mfma_f32_16x16x32_bf16 v[64:67], v[152:155], v[128:131], v[64:67]
    v_mfma_f32_16x16x32_bf16 v[68:71], v[152:155], v[132:135], v[68:71]
    ds_read_b64_tr_b16 v[188:189], v15 offset:32768
    v_mfma_f32_16x16x32_bf16 v[72:75], v[152:155], v[136:139], v[72:75]
    ds_read_b64_tr_b16 v[190:191], v15 offset:33280
    v_mfma_f32_16x16x32_bf16 v[76:79], v[152:155], v[140:143], v[76:79]
    v_mfma_f32_16x16x32_bf16 v[80:83], v[156:159], v[128:131], v[80:83]
    ds_read_b64_tr_b16 v[192:193], v16 offset:32768
    v_mfma_f32_16x16x32_bf16 v[84:87], v[156:159], v[132:135], v[84:87]
    ds_read_b64_tr_b16 v[194:195], v16 offset:33280
    v_mfma_f32_16x16x32_bf16 v[88:91], v[156:159], v[136:139], v[88:91]
    v_mfma_f32_16x16x32_bf16 v[92:95], v[156:159], v[140:143], v[92:95]
    ds_read_b64_tr_b16 v[196:197], v17 offset:32768
    v_mfma_f32_16x16x32_bf16 v[96:99], v[160:163], v[128:131], v[96:99]
    ds_read_b64_tr_b16 v[198:199], v17 offset:33280
    v_mfma_f32_16x16x32_bf16 v[100:103], v[160:163], v[132:135], v[100:103]
    v_mfma_f32_16x16x32_bf16 v[104:107], v[160:163], v[136:139], v[104:107]
    ds_read_b64_tr_b16 v[200:201], v18 offset:32768
    v_mfma_f32_16x16x32_bf16 v[108:111], v[160:163], v[140:143], v[108:111]
    ds_read_b64_tr_b16 v[202:203], v18 offset:33280
    v_mfma_f32_16x16x32_bf16 v[112:115], v[164:167], v[128:131], v[112:115]
    v_mfma_f32_16x16x32_bf16 v[116:119], v[164:167], v[132:135], v[116:119]
    ds_read_b64_tr_b16 v[204:205], v19 offset:32768
    v_mfma_f32_16x16x32_bf16 v[120:123], v[164:167], v[136:139], v[120:123]
    ds_read_b64_tr_b16 v[206:207], v19 offset:33280
    v_mfma_f32_16x16x32_bf16 v[124:127], v[164:167], v[140:143], v[124:127]
    s_waitcnt vmcnt(8) lgkmcnt(0)
    s_barrier
    s_add_u32 m0, s37, 98304
    s_nop 0
    buffer_load_dwordx4 v2, s[16:19], s35 offen lds
    s_add_u32 m0, s38, 98304
    s_add_u32 s35, s35, 64
    buffer_load_dwordx4 v3, s[20:23], s36 offen lds
    s_add_u32 m0, s39, 98304
    s_nop 0
    buffer_load_dwordx4 v4, s[20:23], s36 offen lds
    s_add_u32 m0, s40, 98304
    s_nop 0
    buffer_load_dwordx4 v5, s[20:23], s36 offen lds
    s_add_u32 s36, s36, s47
    v_mfma_f32_16x16x32_bf16 v[32:35], v[184:187], v[168:171], v[32:35]
    ds_read_b64_tr_b16 v[144:145], v8 offset:0
    v_mfma_f32_16x16x32_bf16 v[36:39], v[184:187], v[172:175], v[36:39]
    ds_read_b64_tr_b16 v[146:147], v8 offset:512
    v_mfma_f32_16x16x32_bf16 v[40:43], v[184:187], v[176:179], v[40:43]
    v_mfma_f32_16x16x32_bf16 v[44:47], v[184:187], v[180:183], v[44:47]
    ds_read_b128 v[128:131], v6 offset:0
    v_mfma_f32_16x16x32_bf16 v[48:51], v[188:191], v[168:171], v[48:51]
    ds_read_b128 v[132:135], v6 offset:1024
    v_mfma_f32_16x16x32_bf16 v[52:55], v[188:191], v[172:175], v[52:55]
    v_mfma_f32_16x16x32_bf16 v[56:59], v[188:191], v[176:179], v[56:59]
    ds_read_b128 v[136:139], v6 offset:2048
    v_mfma_f32_16x16x32_bf16 v[60:63], v[188:191], v[180:183], v[60:63]
    ds_read_b128 v[140:143], v6 offset:3072
    v_mfma_f32_16x16x32_bf16 v[64:67], v[192:195], v[168:171], v[64:67]
    v_mfma_f32_16x16x32_bf16 v[68:71], v[192:195], v[172:175], v[68:71]
    ds_read_b64_tr_b16 v[148:149], v9 offset:0
    v_mfma_f32_16x16x32_bf16 v[72:75], v[192:195], v[176:179], v[72:75]
    ds_read_b64_tr_b16 v[150:151], v9 offset:512
    v_mfma_f32_16x16x32_bf16 v[76:79], v[192:195], v[180:183], v[76:79]
    v_mfma_f32_16x16x32_bf16 v[80:83], v[196:199], v[168:171], v[80:83]
    ds_read_b64_tr_b16 v[152:153], v10 offset:0
    v_mfma_f32_16x16x32_bf16 v[84:87], v[196:199], v[172:175], v[84:87]
    ds_read_b64_tr_b16 v[154:155], v10 offset:512
    v_mfma_f32_16x16x32_bf16 v[88:91], v[196:199], v[176:179], v[88:91]
    v_mfma_f32_16x16x32_bf16 v[92:95], v[196:199], v[180:183], v[92:95]
    ds_read_b64_tr_b16 v[156:157], v11 offset:0
    v_mfma_f32_16x16x32_bf16 v[96:99], v[200:203], v[168:171], v[96:99]
    ds_read_b64_tr_b16 v[158:159], v11 offset:512
    v_mfma_f32_16x16x32_bf16 v[100:103], v[200:203], v[172:175], v[100:103]
    v_mfma_f32_16x16x32_bf16 v[104:107], v[200:203], v[176:179], v[104:107]
    ds_read_b64_tr_b16 v[160:161], v12 offset:0
    v_mfma_f32_16x16x32_bf16 v[108:111], v[200:203], v[180:183], v[108:111]
    ds_read_b64_tr_b16 v[162:163], v12 offset:512
    v_mfma_f32_16x16x32_bf16 v[112:115], v[204:207], v[168:171], v[112:115]
    v_mfma_f32_16x16x32_bf16 v[116:119], v[204:207], v[172:175], v[116:119]
    ds_read_b64_tr_b16 v[164:165], v13 offset:0
    v_mfma_f32_16x16x32_bf16 v[120:123], v[204:207], v[176:179], v[120:123]
    ds_read_b64_tr_b16 v[166:167], v13 offset:512
    v_mfma_f32_16x16x32_bf16 v[124:127], v[204:207], v[180:183], v[124:127]
    s_waitcnt vmcnt(8) lgkmcnt(0)
    s_barrier
    s_add_u32 m0, s37, 0
    s_nop 0
    buffer_load_dwordx4 v2, s[16:19], s35 offen lds
    s_add_u32 m0, s38, 0
    s_add_u32 s35, s35, 64
    buffer_load_dwordx4 v3, s[20:23], s36 offen lds
    s_add_u32 m0, s39, 0
    s_nop 0
    buffer_load_dwordx4 v4, s[20:23], s36 offen lds
    s_add_u32 m0, s40, 0
    s_nop 0
    buffer_load_dwordx4 v5, s[20:23], s36 offen lds
    s_add_u32 s36, s36, s47
    v_mfma_f32_16x16x32_bf16 v[32:35], v[144:147], v[128:131], v[32:35]
    ds_read_b64_tr_b16 v[184:185], v8 offset:32768
    v_mfma_f32_16x16x32_bf16 v[36:39], v[144:147], v[132:135], v[36:39]
    ds_read_b64_tr_b16 v[186:187], v8 offset:33280
    v_mfma_f32_16x16x32_bf16 v[40:43], v[144:147], v[136:139], v[40:43]
    v_mfma_f32_16x16x32_bf16 v[44:47], v[144:147], v[140:143], v[44:47]
    ds_read_b128 v[168:171], v6 offset:32768
    v_mfma_f32_16x16x32_bf16 v[48:51], v[148:151], v[128:131], v[48:51]
    ds_read_b128 v[172:175], v6 offset:33792
    v_mfma_f32_16x16x32_bf16 v[52:55], v[148:151], v[132:135], v[52:55]
    v_mfma_f32_16x16x32_bf16 v[56:59], v[148:151], v[136:139], v[56:59]
    ds_read_b128 v[176:179], v6 offset:34816
    v_mfma_f32_16x16x32_bf16 v[60:63], v[148:151], v[140:143], v[60:63]
    ds_read_b128 v[180:183], v6 offset:35840
    v_mfma_f32_16x16x32_bf16 v[64:67], v[152:155], v[128:131], v[64:67]
    v_mfma_f32_16x16x32_bf16 v[68:71], v[152:155], v[132:135], v[68:71]
    ds_read_b64_tr_b16 v[188:189], v9 offset:32768
    v_mfma_f32_16x16x32_bf16 v[72:75], v[152:155], v[136:139], v[72:75]
    ds_read_b64_tr_b16 v[190:191], v9 offset:33280
    v_mfma_f32_16x16x32_bf16 v[76:79], v[152:155], v[140:143], v[76:79]
    v_mfma_f32_16x16x32_bf16 v[80:83], v[156:159], v[128:131], v[80:83]
    ds_read_b64_tr_b16 v[192:193], v10 offset:32768
    v_mfma_f32_16x16x32_bf16 v[84:87], v[156:159], v[132:135], v[84:87]
    ds_read_b64_tr_b16 v[194:195], v10 offset:33280
    v_mfma_f32_16x16x32_bf16 v[88:91], v[156:159], v[136:139], v[88:91]
    v_mfma_f32_16x16x32_bf16 v[92:95], v[156:159], v[140:143], v[92:95]
    ds_read_b64_tr_b16 v[196:197], v11 offset:32768
    v_mfma_f32_16x16x32_bf16 v[96:99], v[160:163], v[128:131], v[96:99]
    ds_read_b64_tr_b16 v[198:199], v11 offset:33280
    v_mfma_f32_16x16x32_bf16 v[100:103], v[160:163], v[132:135], v[100:103]
    v_mfma_f32_16x16x32_bf16 v[104:107], v[160:163], v[136:139], v[104:107]
    ds_read_b64_tr_b16 v[200:201], v12 offset:32768
    v_mfma_f32_16x16x32_bf16 v[108:111], v[160:163], v[140:143], v[108:111]
    ds_read_b64_tr_b16 v[202:203], v12 offset:33280
    v_mfma_f32_16x16x32_bf16 v[112:115], v[164:167], v[128:131], v[112:115]
    v_mfma_f32_16x16x32_bf16 v[116:119], v[164:167], v[132:135], v[116:119]
    ds_read_b64_tr_b16 v[204:205], v13 offset:32768
    v_mfma_f32_16x16x32_bf16 v[120:123], v[164:167], v[136:139], v[120:123]
    ds_read_b64_tr_b16 v[206:207], v13 offset:33280
    v_mfma_f32_16x16x32_bf16 v[124:127], v[164:167], v[140:143], v[124:127]
    s_waitcnt vmcnt(8) lgkmcnt(0)
    s_barrier
    s_add_u32 m0, s37, 32768
    s_nop 0
    buffer_load_dwordx4 v2, s[16:19], s35 offen lds
    s_add_u32 m0, s38, 32768
    s_add_u32 s35, s35, 64
    buffer_load_dwordx4 v3, s[20:23], s36 offen lds
    s_add_u32 m0, s39, 32768
    s_nop 0
    buffer_load_dwordx4 v4, s[20:23], s36 offen lds
    s_add_u32 m0, s40, 32768
    s_nop 0
    buffer_load_dwordx4 v5, s[20:23], s36 offen lds
    s_add_u32 s36, s36, s47
    v_mfma_f32_16x16x32_bf16 v[32:35], v[184:187], v[168:171], v[32:35]
    ds_read_b64_tr_b16 v[144:145], v14 offset:0
    v_mfma_f32_16x16x32_bf16 v[36:39], v[184:187], v[172:175], v[36:39]
    ds_read_b64_tr_b16 v[146:147], v14 offset:512
    v_mfma_f32_16x16x32_bf16 v[40:43], v[184:187], v[176:179], v[40:43]
    v_mfma_f32_16x16x32_bf16 v[44:47], v[184:187], v[180:183], v[44:47]
    ds_read_b128 v[128:131], v7 offset:0
    v_mfma_f32_16x16x32_bf16 v[48:51], v[188:191], v[168:171], v[48:51]
    ds_read_b128 v[132:135], v7 offset:1024
    v_mfma_f32_16x16x32_bf16 v[52:55], v[188:191], v[172:175], v[52:55]
    v_mfma_f32_16x16x32_bf16 v[56:59], v[188:191], v[176:179], v[56:59]
    ds_read_b128 v[136:139], v7 offset:2048
    v_mfma_f32_16x16x32_bf16 v[60:63], v[188:191], v[180:183], v[60:63]
    ds_read_b128 v[140:143], v7 offset:3072
    v_mfma_f32_16x16x32_bf16 v[64:67], v[192:195], v[168:171], v[64:67]
    v_mfma_f32_16x16x32_bf16 v[68:71], v[192:195], v[172:175], v[68:71]
    ds_read_b64_tr_b16 v[148:149], v15 offset:0
    v_mfma_f32_16x16x32_bf16 v[72:75], v[192:195], v[176:179], v[72:75]
    ds_read_b64_tr_b16 v[150:151], v15 offset:512
    v_mfma_f32_16x16x32_bf16 v[76:79], v[192:195], v[180:183], v[76:79]
    v_mfma_f32_16x16x32_bf16 v[80:83], v[196:199], v[168:171], v[80:83]
    ds_read_b64_tr_b16 v[152:153], v16 offset:0
    v_mfma_f32_16x16x32_bf16 v[84:87], v[196:199], v[172:175], v[84:87]
    ds_read_b64_tr_b16 v[154:155], v16 offset:512
    v_mfma_f32_16x16x32_bf16 v[88:91], v[196:199], v[176:179], v[88:91]
    v_mfma_f32_16x16x32_bf16 v[92:95], v[196:199], v[180:183], v[92:95]
    ds_read_b64_tr_b16 v[156:157], v17 offset:0
    v_mfma_f32_16x16x32_bf16 v[96:99], v[200:203], v[168:171], v[96:99]
    ds_read_b64_tr_b16 v[158:159], v17 offset:512
    v_mfma_f32_16x16x32_bf16 v[100:103], v[200:203], v[172:175], v[100:103]
    v_mfma_f32_16x16x32_bf16 v[104:107], v[200:203], v[176:179], v[104:107]
    ds_read_b64_tr_b16 v[160:161], v18 offset:0
    v_mfma_f32_16x16x32_bf16 v[108:111], v[200:203], v[180:183], v[108:111]
    ds_read_b64_tr_b16 v[162:163], v18 offset:512
    v_mfma_f32_16x16x32_bf16 v[112:115], v[204:207], v[168:171], v[112:115]
    v_mfma_f32_16x16x32_bf16 v[116:119], v[204:207], v[172:175], v[116:119]
    ds_read_b64_tr_b16 v[164:165], v19 offset:0
    v_mfma_f32_16x16x32_bf16 v[120:123], v[204:207], v[176:179], v[120:123]
    ds_read_b64_tr_b16 v[166:167], v19 offset:512
    v_mfma_f32_16x16x32_bf16 v[124:127], v[204:207], v[180:183], v[124:127]
    s_waitcnt vmcnt(8) lgkmcnt(0)
    s_barrier
    s_add_u32 m0, s37, 65536
    s_nop 0
    buffer_load_dwordx4 v2, s[16:19], s35 offen lds
    s_add_u32 m0, s38, 65536
    s_add_u32 s35, s35, 64
    buffer_load_dwordx4 v3, s[20:23], s36 offen lds
    s_add_u32 m0, s39, 65536
    s_nop 0
    buffer_load_dwordx4 v4, s[20:23], s36 offen lds
    s_add_u32 m0, s40, 65536
    s_nop 0
    buffer_load_dwordx4 v5, s[20:23], s36 offen lds
    s_add_u32 s36, s36, s47
    v_mfma_f32_16x16x32_bf16 v[32:35], v[144:147], v[128:131], v[32:35]
    ds_read_b64_tr_b16 v[184:185], v14 offset:32768
    v_mfma_f32_16x16x32_bf16 v[36:39], v[144:147], v[132:135], v[36:39]
    ds_read_b64_tr_b16 v[186:187], v14 offset:33280
    v_mfma_f32_16x16x32_bf16 v[40:43], v[144:147], v[136:139], v[40:43]
    v_mfma_f32_16x16x32_bf16 v[44:47], v[144:147], v[140:143], v[44:47]
    ds_read_b128 v[168:171], v7 offset:32768
    v_mfma_f32_16x16x32_bf16 v[48:51], v[148:151], v[128:131], v[48:51]
    ds_read_b128 v[172:175], v7 offset:33792
    v_mfma_f32_16x16x32_bf16 v[52:55], v[148:151], v[132:135], v[52:55]
    v_mfma_f32_16x16x32_bf16 v[56:59], v[148:151], v[136:139], v[56:59]
    ds_read_b128 v[176:179], v7 offset:34816
    v_mfma_f32_16x16x32_bf16 v[60:63], v[148:151], v[140:143], v[60:63]
    ds_read_b128 v[180:183], v7 offset:35840
    v_mfma_f32_16x16x32_bf16 v[64:67], v[152:155], v[128:131], v[64:67]
    v_mfma_f32_16x16x32_bf16 v[68:71], v[152:155], v[132:135], v[68:71]
    ds_read_b64_tr_b16 v[188:189], v15 offset:32768
    v_mfma_f32_16x16x32_bf16 v[72:75], v[152:155], v[136:139], v[72:75]
    ds_read_b64_tr_b16 v[190:191], v15 offset:33280
    v_mfma_f32_16x16x32_bf16 v[76:79], v[152:155], v[140:143], v[76:79]
    v_mfma_f32_16x16x32_bf16 v[80:83], v[156:159], v[128:131], v[80:83]
    ds_read_b64_tr_b16 v[192:193], v16 offset:32768
    v_mfma_f32_16x16x32_bf16 v[84:87], v[156:159], v[132:135], v[84:87]
    ds_read_b64_tr_b16 v[194:195], v16 offset:33280
    v_mfma_f32_16x16x32_bf16 v[88:91], v[156:159], v[136:139], v[88:91]
    v_mfma_f32_16x16x32_bf16 v[92:95], v[156:159], v[140:143], v[92:95]
    ds_read_b64_tr_b16 v[196:197], v17 offset:32768
    v_mfma_f32_16x16x32_bf16 v[96:99], v[160:163], v[128:131], v[96:99]
    ds_read_b64_tr_b16 v[198:199], v17 offset:33280
    v_mfma_f32_16x16x32_bf16 v[100:103], v[160:163], v[132:135], v[100:103]
    v_mfma_f32_16x16x32_bf16 v[104:107], v[160:163], v[136:139], v[104:107]
    ds_read_b64_tr_b16 v[200:201], v18 offset:32768
    v_mfma_f32_16x16x32_bf16 v[108:111], v[160:163], v[140:143], v[108:111]
    ds_read_b64_tr_b16 v[202:203], v18 offset:33280
    v_mfma_f32_16x16x32_bf16 v[112:115], v[164:167], v[128:131], v[112:115]
    v_mfma_f32_16x16x32_bf16 v[116:119], v[164:167], v[132:135], v[116:119]
    ds_read_b64_tr_b16 v[204:205], v19 offset:32768
    v_mfma_f32_16x16x32_bf16 v[120:123], v[164:167], v[136:139], v[120:123]
    ds_read_b64_tr_b16 v[206:207], v19 offset:33280
    v_mfma_f32_16x16x32_bf16 v[124:127], v[164:167], v[140:143], v[124:127]
    s_waitcnt vmcnt(8) lgkmcnt(0)
    s_barrier
    s_add_u32 m0, s37, 98304
    s_nop 0
    buffer_load_dwordx4 v2, s[16:19], s35 offen lds
    s_add_u32 m0, s38, 98304
    s_add_u32 s35, s35, 64
    buffer_load_dwordx4 v3, s[20:23], s36 offen lds
    s_add_u32 m0, s39, 98304
    s_nop 0
    buffer_load_dwordx4 v4, s[20:23], s36 offen lds
    s_add_u32 m0, s40, 98304
    s_nop 0
    buffer_load_dwordx4 v5, s[20:23], s36 offen lds
    s_add_u32 s36, s36, s47
    v_mfma_f32_16x16x32_bf16 v[32:35], v[184:187], v[168:171], v[32:35]
    ds_read_b64_tr_b16 v[144:145], v8 offset:0
    v_mfma_f32_16x16x32_bf16 v[36:39], v[184:187], v[172:175], v[36:39]
    ds_read_b64_tr_b16 v[146:147], v8 offset:512
    v_mfma_f32_16x16x32_bf16 v[40:43], v[184:187], v[176:179], v[40:43]
    v_mfma_f32_16x16x32_bf16 v[44:47], v[184:187], v[180:183], v[44:47]
    ds_read_b128 v[128:131], v6 offset:0
    v_mfma_f32_16x16x32_bf16 v[48:51], v[188:191], v[168:171], v[48:51]
    ds_read_b128 v[132:135], v6 offset:1024
    v_mfma_f32_16x16x32_bf16 v[52:55], v[188:191], v[172:175], v[52:55]
    v_mfma_f32_16x16x32_bf16 v[56:59], v[188:191], v[176:179], v[56:59]
    ds_read_b128 v[136:139], v6 offset:2048
    v_mfma_f32_16x16x32_bf16 v[60:63], v[188:191], v[180:183], v[60:63]
    ds_read_b128 v[140:143], v6 offset:3072
    v_mfma_f32_16x16x32_bf16 v[64:67], v[192:195], v[168:171], v[64:67]
    v_mfma_f32_16x16x32_bf16 v[68:71], v[192:195], v[172:175], v[68:71]
    ds_read_b64_tr_b16 v[148:149], v9 offset:0
    v_mfma_f32_16x16x32_bf16 v[72:75], v[192:195], v[176:179], v[72:75]
    ds_read_b64_tr_b16 v[150:151], v9 offset:512
    v_mfma_f32_16x16x32_bf16 v[76:79], v[192:195], v[180:183], v[76:79]
    v_mfma_f32_16x16x32_bf16 v[80:83], v[196:199], v[168:171], v[80:83]
    ds_read_b64_tr_b16 v[152:153], v10 offset:0
    v_mfma_f32_16x16x32_bf16 v[84:87], v[196:199], v[172:175], v[84:87]
    ds_read_b64_tr_b16 v[154:155], v10 offset:512
    v_mfma_f32_16x16x32_bf16 v[88:91], v[196:199], v[176:179], v[88:91]
    v_mfma_f32_16x16x32_bf16 v[92:95], v[196:199], v[180:183], v[92:95]
    ds_read_b64_tr_b16 v[156:157], v11 offset:0
    v_mfma_f32_16x16x32_bf16 v[96:99], v[200:203], v[168:171], v[96:99]
    ds_read_b64_tr_b16 v[158:159], v11 offset:512
    v_mfma_f32_16x16x32_bf16 v[100:103], v[200:203], v[172:175], v[100:103]
    v_mfma_f32_16x16x32_bf16 v[104:107], v[200:203], v[176:179], v[104:107]
    ds_read_b64_tr_b16 v[160:161], v12 offset:0
    v_mfma_f32_16x16x32_bf16 v[108:111], v[200:203], v[180:183], v[108:111]
    ds_read_b64_tr_b16 v[162:163], v12 offset:512
    v_mfma_f32_16x16x32_bf16 v[112:115], v[204:207], v[168:171], v[112:115]
    v_mfma_f32_16x16x32_bf16 v[116:119], v[204:207], v[172:175], v[116:119]
    ds_read_b64_tr_b16 v[164:165], v13 offset:0
    v_mfma_f32_16x16x32_bf16 v[120:123], v[204:207], v[176:179], v[120:123]
    ds_read_b64_tr_b16 v[166:167], v13 offset:512
    v_mfma_f32_16x16x32_bf16 v[124:127], v[204:207], v[180:183], v[124:127]
    s_waitcnt vmcnt(8) lgkmcnt(0)
    s_barrier
    v_mfma_f32_16x16x32_bf16 v[32:35], v[144:147], v[128:131], v[32:35]
    ds_read_b64_tr_b16 v[184:185], v8 offset:32768
    v_mfma_f32_16x16x32_bf16 v[36:39], v[144:147], v[132:135], v[36:39]
    ds_read_b64_tr_b16 v[186:187], v8 offset:33280
    v_mfma_f32_16x16x32_bf16 v[40:43], v[144:147], v[136:139], v[40:43]
    v_mfma_f32_16x16x32_bf16 v[44:47], v[144:147], v[140:143], v[44:47]
    ds_read_b128 v[168:171], v6 offset:32768
    v_mfma_f32_16x16x32_bf16 v[48:51], v[148:151], v[128:131], v[48:51]
    ds_read_b128 v[172:175], v6 offset:33792
    v_mfma_f32_16x16x32_bf16 v[52:55], v[148:151], v[132:135], v[52:55]
    v_mfma_f32_16x16x32_bf16 v[56:59], v[148:151], v[136:139], v[56:59]
    ds_read_b128 v[176:179], v6 offset:34816
    v_mfma_f32_16x16x32_bf16 v[60:63], v[148:151], v[140:143], v[60:63]
    ds_read_b128 v[180:183], v6 offset:35840
    v_mfma_f32_16x16x32_bf16 v[64:67], v[152:155], v[128:131], v[64:67]
    v_mfma_f32_16x16x32_bf16 v[68:71], v[152:155], v[132:135], v[68:71]
    ds_read_b64_tr_b16 v[188:189], v9 offset:32768
    v_mfma_f32_16x16x32_bf16 v[72:75], v[152:155], v[136:139], v[72:75]
    ds_read_b64_tr_b16 v[190:191], v9 offset:33280
    v_mfma_f32_16x16x32_bf16 v[76:79], v[152:155], v[140:143], v[76:79]
    v_mfma_f32_16x16x32_bf16 v[80:83], v[156:159], v[128:131], v[80:83]
    ds_read_b64_tr_b16 v[192:193], v10 offset:32768
    v_mfma_f32_16x16x32_bf16 v[84:87], v[156:159], v[132:135], v[84:87]
    ds_read_b64_tr_b16 v[194:195], v10 offset:33280
    v_mfma_f32_16x16x32_bf16 v[88:91], v[156:159], v[136:139], v[88:91]
    v_mfma_f32_16x16x32_bf16 v[92:95], v[156:159], v[140:143], v[92:95]
    ds_read_b64_tr_b16 v[196:197], v11 offset:32768
    v_mfma_f32_16x16x32_bf16 v[96:99], v[160:163], v[128:131], v[96:99]
    ds_read_b64_tr_b16 v[198:199], v11 offset:33280
    v_mfma_f32_16x16x32_bf16 v[100:103], v[160:163], v[132:135], v[100:103]
    v_mfma_f32_16x16x32_bf16 v[104:107], v[160:163], v[136:139], v[104:107]
    ds_read_b64_tr_b16 v[200:201], v12 offset:32768
    v_mfma_f32_16x16x32_bf16 v[108:111], v[160:163], v[140:143], v[108:111]
    ds_read_b64_tr_b16 v[202:203], v12 offset:33280
    v_mfma_f32_16x16x32_bf16 v[112:115], v[164:167], v[128:131], v[112:115]
    v_mfma_f32_16x16x32_bf16 v[116:119], v[164:167], v[132:135], v[116:119]
    ds_read_b64_tr_b16 v[204:205], v13 offset:32768
    v_mfma_f32_16x16x32_bf16 v[120:123], v[164:167], v[136:139], v[120:123]
    ds_read_b64_tr_b16 v[206:207], v13 offset:33280
    v_mfma_f32_16x16x32_bf16 v[124:127], v[164:167], v[140:143], v[124:127]
    s_waitcnt vmcnt(4) lgkmcnt(0)
    s_barrier
    v_mfma_f32_16x16x32_bf16 v[32:35], v[184:187], v[168:171], v[32:35]
    ds_read_b64_tr_b16 v[144:145], v14 offset:0
    v_mfma_f32_16x16x32_bf16 v[36:39], v[184:187], v[172:175], v[36:39]
    ds_read_b64_tr_b16 v[146:147], v14 offset:512
    v_mfma_f32_16x16x32_bf16 v[40:43], v[184:187], v[176:179], v[40:43]
    v_mfma_f32_16x16x32_bf16 v[44:47], v[184:187], v[180:183], v[44:47]
    ds_read_b128 v[128:131], v7 offset:0
    v_mfma_f32_16x16x32_bf16 v[48:51], v[188:191], v[168:171], v[48:51]
    ds_read_b128 v[132:135], v7 offset:1024
    v_mfma_f32_16x16x32_bf16 v[52:55], v[188:191], v[172:175], v[52:55]
    v_mfma_f32_16x16x32_bf16 v[56:59], v[188:191], v[176:179], v[56:59]
    ds_read_b128 v[136:139], v7 offset:2048
    v_mfma_f32_16x16x32_bf16 v[60:63], v[188:191], v[180:183], v[60:63]
    ds_read_b128 v[140:143], v7 offset:3072
    v_mfma_f32_16x16x32_bf16 v[64:67], v[192:195], v[168:171], v[64:67]
    v_mfma_f32_16x16x32_bf16 v[68:71], v[192:195], v[172:175], v[68:71]
    ds_read_b64_tr_b16 v[148:149], v15 offset:0
    v_mfma_f32_16x16x32_bf16 v[72:75], v[192:195], v[176:179], v[72:75]
    ds_read_b64_tr_b16 v[150:151], v15 offset:512
    v_mfma_f32_16x16x32_bf16 v[76:79], v[192:195], v[180:183], v[76:79]
    v_mfma_f32_16x16x32_bf16 v[80:83], v[196:199], v[168:171], v[80:83]
    ds_read_b64_tr_b16 v[152:153], v16 offset:0
    v_mfma_f32_16x16x32_bf16 v[84:87], v[196:199], v[172:175], v[84:87]
    ds_read_b64_tr_b16 v[154:155], v16 offset:512
    v_mfma_f32_16x16x32_bf16 v[88:91], v[196:199], v[176:179], v[88:91]
    v_mfma_f32_16x16x32_bf16 v[92:95], v[196:199], v[180:183], v[92:95]
    ds_read_b64_tr_b16 v[156:157], v17 offset:0
    v_mfma_f32_16x16x32_bf16 v[96:99], v[200:203], v[168:171], v[96:99]
    ds_read_b64_tr_b16 v[158:159], v17 offset:512
    v_mfma_f32_16x16x32_bf16 v[100:103], v[200:203], v[172:175], v[100:103]
    v_mfma_f32_16x16x32_bf16 v[104:107], v[200:203], v[176:179], v[104:107]
    ds_read_b64_tr_b16 v[160:161], v18 offset:0
    v_mfma_f32_16x16x32_bf16 v[108:111], v[200:203], v[180:183], v[108:111]
    ds_read_b64_tr_b16 v[162:163], v18 offset:512
    v_mfma_f32_16x16x32_bf16 v[112:115], v[204:207], v[168:171], v[112:115]
    v_mfma_f32_16x16x32_bf16 v[116:119], v[204:207], v[172:175], v[116:119]
    ds_read_b64_tr_b16 v[164:165], v19 offset:0
    v_mfma_f32_16x16x32_bf16 v[120:123], v[204:207], v[176:179], v[120:123]
    ds_read_b64_tr_b16 v[166:167], v19 offset:512
    v_mfma_f32_16x16x32_bf16 v[124:127], v[204:207], v[180:183], v[124:127]
    s_waitcnt vmcnt(0) lgkmcnt(0)
    s_barrier
    v_mfma_f32_16x16x32_bf16 v[32:35], v[144:147], v[128:131], v[32:35]
    ds_read_b64_tr_b16 v[184:185], v14 offset:32768
    v_mfma_f32_16x16x32_bf16 v[36:39], v[144:147], v[132:135], v[36:39]
    ds_read_b64_tr_b16 v[186:187], v14 offset:33280
    v_mfma_f32_16x16x32_bf16 v[40:43], v[144:147], v[136:139], v[40:43]
    v_mfma_f32_16x16x32_bf16 v[44:47], v[144:147], v[140:143], v[44:47]
    ds_read_b128 v[168:171], v7 offset:32768
    v_mfma_f32_16x16x32_bf16 v[48:51], v[148:151], v[128:131], v[48:51]
    ds_read_b128 v[172:175], v7 offset:33792
    v_mfma_f32_16x16x32_bf16 v[52:55], v[148:151], v[132:135], v[52:55]
    v_mfma_f32_16x16x32_bf16 v[56:59], v[148:151], v[136:139], v[56:59]
    ds_read_b128 v[176:179], v7 offset:34816
    v_mfma_f32_16x16x32_bf16 v[60:63], v[148:151], v[140:143], v[60:63]
    ds_read_b128 v[180:183], v7 offset:35840
    v_mfma_f32_16x16x32_bf16 v[64:67], v[152:155], v[128:131], v[64:67]
    v_mfma_f32_16x16x32_bf16 v[68:71], v[152:155], v[132:135], v[68:71]
    ds_read_b64_tr_b16 v[188:189], v15 offset:32768
    v_mfma_f32_16x16x32_bf16 v[72:75], v[152:155], v[136:139], v[72:75]
    ds_read_b64_tr_b16 v[190:191], v15 offset:33280
    v_mfma_f32_16x16x32_bf16 v[76:79], v[152:155], v[140:143], v[76:79]
    v_mfma_f32_16x16x32_bf16 v[80:83], v[156:159], v[128:131], v[80:83]
    ds_read_b64_tr_b16 v[192:193], v16 offset:32768
    v_mfma_f32_16x16x32_bf16 v[84:87], v[156:159], v[132:135], v[84:87]
    ds_read_b64_tr_b16 v[194:195], v16 offset:33280
    v_mfma_f32_16x16x32_bf16 v[88:91], v[156:159], v[136:139], v[88:91]
    v_mfma_f32_16x16x32_bf16 v[92:95], v[156:159], v[140:143], v[92:95]
    ds_read_b64_tr_b16 v[196:197], v17 offset:32768
    v_mfma_f32_16x16x32_bf16 v[96:99], v[160:163], v[128:131], v[96:99]
    ds_read_b64_tr_b16 v[198:199], v17 offset:33280
    v_mfma_f32_16x16x32_bf16 v[100:103], v[160:163], v[132:135], v[100:103]
    v_mfma_f32_16x16x32_bf16 v[104:107], v[160:163], v[136:139], v[104:107]
    ds_read_b64_tr_b16 v[200:201], v18 offset:32768
    v_mfma_f32_16x16x32_bf16 v[108:111], v[160:163], v[140:143], v[108:111]
    ds_read_b64_tr_b16 v[202:203], v18 offset:33280
    v_mfma_f32_16x16x32_bf16 v[112:115], v[164:167], v[128:131], v[112:115]
    v_mfma_f32_16x16x32_bf16 v[116:119], v[164:167], v[132:135], v[116:119]
    ds_read_b64_tr_b16 v[204:205], v19 offset:32768
    v_mfma_f32_16x16x32_bf16 v[120:123], v[164:167], v[136:139], v[120:123]
    ds_read_b64_tr_b16 v[206:207], v19 offset:33280
    v_mfma_f32_16x16x32_bf16 v[124:127], v[164:167], v[140:143], v[124:127]
    s_waitcnt vmcnt(0) lgkmcnt(0)
    s_barrier
    v_mfma_f32_16x16x32_bf16 v[32:35], v[184:187], v[168:171], v[32:35]
    v_mfma_f32_16x16x32_bf16 v[36:39], v[184:187], v[172:175], v[36:39]
    v_mfma_f32_16x16x32_bf16 v[40:43], v[184:187], v[176:179], v[40:43]
    v_mfma_f32_16x16x32_bf16 v[44:47], v[184:187], v[180:183], v[44:47]
    v_mfma_f32_16x16x32_bf16 v[48:51], v[188:191], v[168:171], v[48:51]
    v_mfma_f32_16x16x32_bf16 v[52:55], v[188:191], v[172:175], v[52:55]
    v_mfma_f32_16x16x32_bf16 v[56:59], v[188:191], v[176:179], v[56:59]
    v_mfma_f32_16x16x32_bf16 v[60:63], v[188:191], v[180:183], v[60:63]
    v_mfma_f32_16x16x32_bf16 v[64:67], v[192:195], v[168:171], v[64:67]
    v_mfma_f32_16x16x32_bf16 v[68:71], v[192:195], v[172:175], v[68:71]
    v_mfma_f32_16x16x32_bf16 v[72:75], v[192:195], v[176:179], v[72:75]
    v_mfma_f32_16x16x32_bf16 v[76:79], v[192:195], v[180:183], v[76:79]
    v_mfma_f32_16x16x32_bf16 v[80:83], v[196:199], v[168:171], v[80:83]
    v_mfma_f32_16x16x32_bf16 v[84:87], v[196:199], v[172:175], v[84:87]
    v_mfma_f32_16x16x32_bf16 v[88:91], v[196:199], v[176:179], v[88:91]
    v_mfma_f32_16x16x32_bf16 v[92:95], v[196:199], v[180:183], v[92:95]
    v_mfma_f32_16x16x32_bf16 v[96:99], v[200:203], v[168:171], v[96:99]
    v_mfma_f32_16x16x32_bf16 v[100:103], v[200:203], v[172:175], v[100:103]
    v_mfma_f32_16x16x32_bf16 v[104:107], v[200:203], v[176:179], v[104:107]
    v_mfma_f32_16x16x32_bf16 v[108:111], v[200:203], v[180:183], v[108:111]
    v_mfma_f32_16x16x32_bf16 v[112:115], v[204:207], v[168:171], v[112:115]
    v_mfma_f32_16x16x32_bf16 v[116:119], v[204:207], v[172:175], v[116:119]
    v_mfma_f32_16x16x32_bf16 v[120:123], v[204:207], v[176:179], v[120:123]
    v_mfma_f32_16x16x32_bf16 v[124:127], v[204:207], v[180:183], v[124:127]
    s_nop 7
    s_nop 7
    v_and_b32 v20, 15, v1
    s_lshl_b32 s41, s28, 7
    s_lshl_b32 s42, s32, 6
    s_add_u32 s41, s41, s42
    v_add_u32 v20, s41, v20
    v_lshrrev_b32 v21, 4, v1
    v_lshlrev_b32 v21, 2, v21
    s_mul_i32 s41, s31, 48
    s_cmp_ge_u32 s29, 5
    s_cbranch_scc1 k1_kernel_epi_ffn
    s_mul_i32 s42, s29, 384
    s_add_u32 s41, s41, s42
    v_mul_u32_u24 v22, 40, v20
    v_lshrrev_b32 v23, 5, v20
    v_mul_u32_u24 v23, 1280, v23
    v_bfe_u32 v24, v20, 2, 1
    v_lshlrev_b32 v24, 5, v24
    v_add_u32 v23, v23, v24
    v_bfe_u32 v24, v20, 3, 2
    v_lshlrev_b32 v24, 3, v24
    v_add_u32 v23, v23, v24
    v_and_b32 v24, 3, v20
    v_lshlrev_b32 v24, 1, v24
    v_add_u32 v23, v23, v24
    v_add_u32 v23, 5242880, v23
    s_mov_b32 s46, 0xcccd
    s_add_u32 s42, s41, 0
    s_cmp_ge_u32 s42, 1280
    s_cselect_b32 s43, 1280, 0
    s_sub_u32 s43, s42, s43
    v_add_u32 v25, s43, v21
    v_mul_u32_u24 v26, s46, v25
    v_lshrrev_b32 v26, 20, v26
    v_mul_u32_u24 v27, 20, v26
    v_sub_u32 v27, v25, v27
    s_cmp_ge_u32 s42, 1280
    s_cbranch_scc1 k1_kernel_v_0
    v_mul_u32_u24 v26, 81920, v26
    v_lshlrev_b32 v27, 1, v27
    v_add3_u32 v26, v26, v27, v22
    v_cvt_pk_bf16_f32 v128, v32, v33
    v_cvt_pk_bf16_f32 v129, v34, v35
    buffer_store_dwordx2 v[128:129], v26, s[24:27], 0 offen offset:0
    s_nop 1
    v_cvt_pk_bf16_f32 v128, v36, v37
    v_cvt_pk_bf16_f32 v129, v38, v39
    buffer_store_dwordx2 v[128:129], v26, s[24:27], 0 offen offset:640
    s_nop 1
    v_cvt_pk_bf16_f32 v128, v40, v41
    v_cvt_pk_bf16_f32 v129, v42, v43
    buffer_store_dwordx2 v[128:129], v26, s[24:27], 0 offen offset:1280
    s_nop 1
    v_cvt_pk_bf16_f32 v128, v44, v45
    v_cvt_pk_bf16_f32 v129, v46, v47
    buffer_store_dwordx2 v[128:129], v26, s[24:27], 0 offen offset:1920
    s_nop 1
    s_branch k1_kernel_n_0
    k1_kernel_v_0:
    v_mul_u32_u24 v26, 81920, v26
    v_lshlrev_b32 v27, 6, v27
    v_add3_u32 v26, v26, v27, v23
    v_cvt_pk_bf16_f32 v128, v32, v33
    v_cvt_pk_bf16_f32 v129, v34, v35
    buffer_store_short v128, v26, s[24:27], 0 offen offset:0
    buffer_store_short_d16_hi v128, v26, s[24:27], 0 offen offset:64
    buffer_store_short v129, v26, s[24:27], 0 offen offset:128
    buffer_store_short_d16_hi v129, v26, s[24:27], 0 offen offset:192
    s_nop 1
    v_cvt_pk_bf16_f32 v128, v36, v37
    v_cvt_pk_bf16_f32 v129, v38, v39
    buffer_store_short v128, v26, s[24:27], 0 offen offset:16
    buffer_store_short_d16_hi v128, v26, s[24:27], 0 offen offset:80
    buffer_store_short v129, v26, s[24:27], 0 offen offset:144
    buffer_store_short_d16_hi v129, v26, s[24:27], 0 offen offset:208
    s_nop 1
    v_cvt_pk_bf16_f32 v128, v40, v41
    v_cvt_pk_bf16_f32 v129, v42, v43
    buffer_store_short v128, v26, s[24:27], 0 offen offset:1280
    buffer_store_short_d16_hi v128, v26, s[24:27], 0 offen offset:1344
    buffer_store_short v129, v26, s[24:27], 0 offen offset:1408
    buffer_store_short_d16_hi v129, v26, s[24:27], 0 offen offset:1472
    s_nop 1
    v_cvt_pk_bf16_f32 v128, v44, v45
    v_cvt_pk_bf16_f32 v129, v46, v47
    buffer_store_short v128, v26, s[24:27], 0 offen offset:1296
    buffer_store_short_d16_hi v128, v26, s[24:27], 0 offen offset:1360
    buffer_store_short v129, v26, s[24:27], 0 offen offset:1424
    buffer_store_short_d16_hi v129, v26, s[24:27], 0 offen offset:1488
    s_nop 1
    k1_kernel_n_0:
    s_add_u32 s42, s41, 16
    s_cmp_ge_u32 s42, 1280
    s_cselect_b32 s43, 1280, 0
    s_sub_u32 s43, s42, s43
    v_add_u32 v25, s43, v21
    v_mul_u32_u24 v26, s46, v25
    v_lshrrev_b32 v26, 20, v26
    v_mul_u32_u24 v27, 20, v26
    v_sub_u32 v27, v25, v27
    s_cmp_ge_u32 s42, 1280
    s_cbranch_scc1 k1_kernel_v_1
    v_mul_u32_u24 v26, 81920, v26
    v_lshlrev_b32 v27, 1, v27
    v_add3_u32 v26, v26, v27, v22
    v_cvt_pk_bf16_f32 v128, v48, v49
    v_cvt_pk_bf16_f32 v129, v50, v51
    buffer_store_dwordx2 v[128:129], v26, s[24:27], 0 offen offset:0
    s_nop 1
    v_cvt_pk_bf16_f32 v128, v52, v53
    v_cvt_pk_bf16_f32 v129, v54, v55
    buffer_store_dwordx2 v[128:129], v26, s[24:27], 0 offen offset:640
    s_nop 1
    v_cvt_pk_bf16_f32 v128, v56, v57
    v_cvt_pk_bf16_f32 v129, v58, v59
    buffer_store_dwordx2 v[128:129], v26, s[24:27], 0 offen offset:1280
    s_nop 1
    v_cvt_pk_bf16_f32 v128, v60, v61
    v_cvt_pk_bf16_f32 v129, v62, v63
    buffer_store_dwordx2 v[128:129], v26, s[24:27], 0 offen offset:1920
    s_nop 1
    s_branch k1_kernel_n_1
    k1_kernel_v_1:
    v_mul_u32_u24 v26, 81920, v26
    v_lshlrev_b32 v27, 6, v27
    v_add3_u32 v26, v26, v27, v23
    v_cvt_pk_bf16_f32 v128, v48, v49
    v_cvt_pk_bf16_f32 v129, v50, v51
    buffer_store_short v128, v26, s[24:27], 0 offen offset:0
    buffer_store_short_d16_hi v128, v26, s[24:27], 0 offen offset:64
    buffer_store_short v129, v26, s[24:27], 0 offen offset:128
    buffer_store_short_d16_hi v129, v26, s[24:27], 0 offen offset:192
    s_nop 1
    v_cvt_pk_bf16_f32 v128, v52, v53
    v_cvt_pk_bf16_f32 v129, v54, v55
    buffer_store_short v128, v26, s[24:27], 0 offen offset:16
    buffer_store_short_d16_hi v128, v26, s[24:27], 0 offen offset:80
    buffer_store_short v129, v26, s[24:27], 0 offen offset:144
    buffer_store_short_d16_hi v129, v26, s[24:27], 0 offen offset:208
    s_nop 1
    v_cvt_pk_bf16_f32 v128, v56, v57
    v_cvt_pk_bf16_f32 v129, v58, v59
    buffer_store_short v128, v26, s[24:27], 0 offen offset:1280
    buffer_store_short_d16_hi v128, v26, s[24:27], 0 offen offset:1344
    buffer_store_short v129, v26, s[24:27], 0 offen offset:1408
    buffer_store_short_d16_hi v129, v26, s[24:27], 0 offen offset:1472
    s_nop 1
    v_cvt_pk_bf16_f32 v128, v60, v61
    v_cvt_pk_bf16_f32 v129, v62, v63
    buffer_store_short v128, v26, s[24:27], 0 offen offset:1296
    buffer_store_short_d16_hi v128, v26, s[24:27], 0 offen offset:1360
    buffer_store_short v129, v26, s[24:27], 0 offen offset:1424
    buffer_store_short_d16_hi v129, v26, s[24:27], 0 offen offset:1488
    s_nop 1
    k1_kernel_n_1:
    s_add_u32 s42, s41, 32
    s_cmp_ge_u32 s42, 1280
    s_cselect_b32 s43, 1280, 0
    s_sub_u32 s43, s42, s43
    v_add_u32 v25, s43, v21
    v_mul_u32_u24 v26, s46, v25
    v_lshrrev_b32 v26, 20, v26
    v_mul_u32_u24 v27, 20, v26
    v_sub_u32 v27, v25, v27
    s_cmp_ge_u32 s42, 1280
    s_cbranch_scc1 k1_kernel_v_2
    v_mul_u32_u24 v26, 81920, v26
    v_lshlrev_b32 v27, 1, v27
    v_add3_u32 v26, v26, v27, v22
    v_cvt_pk_bf16_f32 v128, v64, v65
    v_cvt_pk_bf16_f32 v129, v66, v67
    buffer_store_dwordx2 v[128:129], v26, s[24:27], 0 offen offset:0
    s_nop 1
    v_cvt_pk_bf16_f32 v128, v68, v69
    v_cvt_pk_bf16_f32 v129, v70, v71
    buffer_store_dwordx2 v[128:129], v26, s[24:27], 0 offen offset:640
    s_nop 1
    v_cvt_pk_bf16_f32 v128, v72, v73
    v_cvt_pk_bf16_f32 v129, v74, v75
    buffer_store_dwordx2 v[128:129], v26, s[24:27], 0 offen offset:1280
    s_nop 1
    v_cvt_pk_bf16_f32 v128, v76, v77
    v_cvt_pk_bf16_f32 v129, v78, v79
    buffer_store_dwordx2 v[128:129], v26, s[24:27], 0 offen offset:1920
    s_nop 1
    s_branch k1_kernel_n_2
    k1_kernel_v_2:
    v_mul_u32_u24 v26, 81920, v26
    v_lshlrev_b32 v27, 6, v27
    v_add3_u32 v26, v26, v27, v23
    v_cvt_pk_bf16_f32 v128, v64, v65
    v_cvt_pk_bf16_f32 v129, v66, v67
    buffer_store_short v128, v26, s[24:27], 0 offen offset:0
    buffer_store_short_d16_hi v128, v26, s[24:27], 0 offen offset:64
    buffer_store_short v129, v26, s[24:27], 0 offen offset:128
    buffer_store_short_d16_hi v129, v26, s[24:27], 0 offen offset:192
    s_nop 1
    v_cvt_pk_bf16_f32 v128, v68, v69
    v_cvt_pk_bf16_f32 v129, v70, v71
    buffer_store_short v128, v26, s[24:27], 0 offen offset:16
    buffer_store_short_d16_hi v128, v26, s[24:27], 0 offen offset:80
    buffer_store_short v129, v26, s[24:27], 0 offen offset:144
    buffer_store_short_d16_hi v129, v26, s[24:27], 0 offen offset:208
    s_nop 1
    v_cvt_pk_bf16_f32 v128, v72, v73
    v_cvt_pk_bf16_f32 v129, v74, v75
    buffer_store_short v128, v26, s[24:27], 0 offen offset:1280
    buffer_store_short_d16_hi v128, v26, s[24:27], 0 offen offset:1344
    buffer_store_short v129, v26, s[24:27], 0 offen offset:1408
    buffer_store_short_d16_hi v129, v26, s[24:27], 0 offen offset:1472
    s_nop 1
    v_cvt_pk_bf16_f32 v128, v76, v77
    v_cvt_pk_bf16_f32 v129, v78, v79
    buffer_store_short v128, v26, s[24:27], 0 offen offset:1296
    buffer_store_short_d16_hi v128, v26, s[24:27], 0 offen offset:1360
    buffer_store_short v129, v26, s[24:27], 0 offen offset:1424
    buffer_store_short_d16_hi v129, v26, s[24:27], 0 offen offset:1488
    s_nop 1
    k1_kernel_n_2:
    s_add_u32 s42, s41, 192
    s_cmp_ge_u32 s42, 1280
    s_cselect_b32 s43, 1280, 0
    s_sub_u32 s43, s42, s43
    v_add_u32 v25, s43, v21
    v_mul_u32_u24 v26, s46, v25
    v_lshrrev_b32 v26, 20, v26
    v_mul_u32_u24 v27, 20, v26
    v_sub_u32 v27, v25, v27
    s_cmp_ge_u32 s42, 1280
    s_cbranch_scc1 k1_kernel_v_3
    v_mul_u32_u24 v26, 81920, v26
    v_lshlrev_b32 v27, 1, v27
    v_add3_u32 v26, v26, v27, v22
    v_cvt_pk_bf16_f32 v128, v80, v81
    v_cvt_pk_bf16_f32 v129, v82, v83
    buffer_store_dwordx2 v[128:129], v26, s[24:27], 0 offen offset:0
    s_nop 1
    v_cvt_pk_bf16_f32 v128, v84, v85
    v_cvt_pk_bf16_f32 v129, v86, v87
    buffer_store_dwordx2 v[128:129], v26, s[24:27], 0 offen offset:640
    s_nop 1
    v_cvt_pk_bf16_f32 v128, v88, v89
    v_cvt_pk_bf16_f32 v129, v90, v91
    buffer_store_dwordx2 v[128:129], v26, s[24:27], 0 offen offset:1280
    s_nop 1
    v_cvt_pk_bf16_f32 v128, v92, v93
    v_cvt_pk_bf16_f32 v129, v94, v95
    buffer_store_dwordx2 v[128:129], v26, s[24:27], 0 offen offset:1920
    s_nop 1
    s_branch k1_kernel_n_3
    k1_kernel_v_3:
    v_mul_u32_u24 v26, 81920, v26
    v_lshlrev_b32 v27, 6, v27
    v_add3_u32 v26, v26, v27, v23
    v_cvt_pk_bf16_f32 v128, v80, v81
    v_cvt_pk_bf16_f32 v129, v82, v83
    buffer_store_short v128, v26, s[24:27], 0 offen offset:0
    buffer_store_short_d16_hi v128, v26, s[24:27], 0 offen offset:64
    buffer_store_short v129, v26, s[24:27], 0 offen offset:128
    buffer_store_short_d16_hi v129, v26, s[24:27], 0 offen offset:192
    s_nop 1
    v_cvt_pk_bf16_f32 v128, v84, v85
    v_cvt_pk_bf16_f32 v129, v86, v87
    buffer_store_short v128, v26, s[24:27], 0 offen offset:16
    buffer_store_short_d16_hi v128, v26, s[24:27], 0 offen offset:80
    buffer_store_short v129, v26, s[24:27], 0 offen offset:144
    buffer_store_short_d16_hi v129, v26, s[24:27], 0 offen offset:208
    s_nop 1
    v_cvt_pk_bf16_f32 v128, v88, v89
    v_cvt_pk_bf16_f32 v129, v90, v91
    buffer_store_short v128, v26, s[24:27], 0 offen offset:1280
    buffer_store_short_d16_hi v128, v26, s[24:27], 0 offen offset:1344
    buffer_store_short v129, v26, s[24:27], 0 offen offset:1408
    buffer_store_short_d16_hi v129, v26, s[24:27], 0 offen offset:1472
    s_nop 1
    v_cvt_pk_bf16_f32 v128, v92, v93
    v_cvt_pk_bf16_f32 v129, v94, v95
    buffer_store_short v128, v26, s[24:27], 0 offen offset:1296
    buffer_store_short_d16_hi v128, v26, s[24:27], 0 offen offset:1360
    buffer_store_short v129, v26, s[24:27], 0 offen offset:1424
    buffer_store_short_d16_hi v129, v26, s[24:27], 0 offen offset:1488
    s_nop 1
    k1_kernel_n_3:
    s_add_u32 s42, s41, 208
    s_cmp_ge_u32 s42, 1280
    s_cselect_b32 s43, 1280, 0
    s_sub_u32 s43, s42, s43
    v_add_u32 v25, s43, v21
    v_mul_u32_u24 v26, s46, v25
    v_lshrrev_b32 v26, 20, v26
    v_mul_u32_u24 v27, 20, v26
    v_sub_u32 v27, v25, v27
    s_cmp_ge_u32 s42, 1280
    s_cbranch_scc1 k1_kernel_v_4
    v_mul_u32_u24 v26, 81920, v26
    v_lshlrev_b32 v27, 1, v27
    v_add3_u32 v26, v26, v27, v22
    v_cvt_pk_bf16_f32 v128, v96, v97
    v_cvt_pk_bf16_f32 v129, v98, v99
    buffer_store_dwordx2 v[128:129], v26, s[24:27], 0 offen offset:0
    s_nop 1
    v_cvt_pk_bf16_f32 v128, v100, v101
    v_cvt_pk_bf16_f32 v129, v102, v103
    buffer_store_dwordx2 v[128:129], v26, s[24:27], 0 offen offset:640
    s_nop 1
    v_cvt_pk_bf16_f32 v128, v104, v105
    v_cvt_pk_bf16_f32 v129, v106, v107
    buffer_store_dwordx2 v[128:129], v26, s[24:27], 0 offen offset:1280
    s_nop 1
    v_cvt_pk_bf16_f32 v128, v108, v109
    v_cvt_pk_bf16_f32 v129, v110, v111
    buffer_store_dwordx2 v[128:129], v26, s[24:27], 0 offen offset:1920
    s_nop 1
    s_branch k1_kernel_n_4
    k1_kernel_v_4:
    v_mul_u32_u24 v26, 81920, v26
    v_lshlrev_b32 v27, 6, v27
    v_add3_u32 v26, v26, v27, v23
    v_cvt_pk_bf16_f32 v128, v96, v97
    v_cvt_pk_bf16_f32 v129, v98, v99
    buffer_store_short v128, v26, s[24:27], 0 offen offset:0
    buffer_store_short_d16_hi v128, v26, s[24:27], 0 offen offset:64
    buffer_store_short v129, v26, s[24:27], 0 offen offset:128
    buffer_store_short_d16_hi v129, v26, s[24:27], 0 offen offset:192
    s_nop 1
    v_cvt_pk_bf16_f32 v128, v100, v101
    v_cvt_pk_bf16_f32 v129, v102, v103
    buffer_store_short v128, v26, s[24:27], 0 offen offset:16
    buffer_store_short_d16_hi v128, v26, s[24:27], 0 offen offset:80
    buffer_store_short v129, v26, s[24:27], 0 offen offset:144
    buffer_store_short_d16_hi v129, v26, s[24:27], 0 offen offset:208
    s_nop 1
    v_cvt_pk_bf16_f32 v128, v104, v105
    v_cvt_pk_bf16_f32 v129, v106, v107
    buffer_store_short v128, v26, s[24:27], 0 offen offset:1280
    buffer_store_short_d16_hi v128, v26, s[24:27], 0 offen offset:1344
    buffer_store_short v129, v26, s[24:27], 0 offen offset:1408
    buffer_store_short_d16_hi v129, v26, s[24:27], 0 offen offset:1472
    s_nop 1
    v_cvt_pk_bf16_f32 v128, v108, v109
    v_cvt_pk_bf16_f32 v129, v110, v111
    buffer_store_short v128, v26, s[24:27], 0 offen offset:1296
    buffer_store_short_d16_hi v128, v26, s[24:27], 0 offen offset:1360
    buffer_store_short v129, v26, s[24:27], 0 offen offset:1424
    buffer_store_short_d16_hi v129, v26, s[24:27], 0 offen offset:1488
    s_nop 1
    k1_kernel_n_4:
    s_add_u32 s42, s41, 224
    s_cmp_ge_u32 s42, 1280
    s_cselect_b32 s43, 1280, 0
    s_sub_u32 s43, s42, s43
    v_add_u32 v25, s43, v21
    v_mul_u32_u24 v26, s46, v25
    v_lshrrev_b32 v26, 20, v26
    v_mul_u32_u24 v27, 20, v26
    v_sub_u32 v27, v25, v27
    s_cmp_ge_u32 s42, 1280
    s_cbranch_scc1 k1_kernel_v_5
    v_mul_u32_u24 v26, 81920, v26
    v_lshlrev_b32 v27, 1, v27
    v_add3_u32 v26, v26, v27, v22
    v_cvt_pk_bf16_f32 v128, v112, v113
    v_cvt_pk_bf16_f32 v129, v114, v115
    buffer_store_dwordx2 v[128:129], v26, s[24:27], 0 offen offset:0
    s_nop 1
    v_cvt_pk_bf16_f32 v128, v116, v117
    v_cvt_pk_bf16_f32 v129, v118, v119
    buffer_store_dwordx2 v[128:129], v26, s[24:27], 0 offen offset:640
    s_nop 1
    v_cvt_pk_bf16_f32 v128, v120, v121
    v_cvt_pk_bf16_f32 v129, v122, v123
    buffer_store_dwordx2 v[128:129], v26, s[24:27], 0 offen offset:1280
    s_nop 1
    v_cvt_pk_bf16_f32 v128, v124, v125
    v_cvt_pk_bf16_f32 v129, v126, v127
    buffer_store_dwordx2 v[128:129], v26, s[24:27], 0 offen offset:1920
    s_nop 1
    s_branch k1_kernel_n_5
    k1_kernel_v_5:
    v_mul_u32_u24 v26, 81920, v26
    v_lshlrev_b32 v27, 6, v27
    v_add3_u32 v26, v26, v27, v23
    v_cvt_pk_bf16_f32 v128, v112, v113
    v_cvt_pk_bf16_f32 v129, v114, v115
    buffer_store_short v128, v26, s[24:27], 0 offen offset:0
    buffer_store_short_d16_hi v128, v26, s[24:27], 0 offen offset:64
    buffer_store_short v129, v26, s[24:27], 0 offen offset:128
    buffer_store_short_d16_hi v129, v26, s[24:27], 0 offen offset:192
    s_nop 1
    v_cvt_pk_bf16_f32 v128, v116, v117
    v_cvt_pk_bf16_f32 v129, v118, v119
    buffer_store_short v128, v26, s[24:27], 0 offen offset:16
    buffer_store_short_d16_hi v128, v26, s[24:27], 0 offen offset:80
    buffer_store_short v129, v26, s[24:27], 0 offen offset:144
    buffer_store_short_d16_hi v129, v26, s[24:27], 0 offen offset:208
    s_nop 1
    v_cvt_pk_bf16_f32 v128, v120, v121
    v_cvt_pk_bf16_f32 v129, v122, v123
    buffer_store_short v128, v26, s[24:27], 0 offen offset:1280
    buffer_store_short_d16_hi v128, v26, s[24:27], 0 offen offset:1344
    buffer_store_short v129, v26, s[24:27], 0 offen offset:1408
    buffer_store_short_d16_hi v129, v26, s[24:27], 0 offen offset:1472
    s_nop 1
    v_cvt_pk_bf16_f32 v128, v124, v125
    v_cvt_pk_bf16_f32 v129, v126, v127
    buffer_store_short v128, v26, s[24:27], 0 offen offset:1296
    buffer_store_short_d16_hi v128, v26, s[24:27], 0 offen offset:1360
    buffer_store_short v129, v26, s[24:27], 0 offen offset:1424
    buffer_store_short_d16_hi v129, v26, s[24:27], 0 offen offset:1488
    s_nop 1
    k1_kernel_n_5:
    s_branch k1_kernel_end
    k1_kernel_epi_ffn:
    s_sub_u32 s42, s29, 5
    s_mul_i32 s42, s42, 192
    s_add_u32 s41, s41, s42
    s_lshl_b32 s41, s41, 1
    s_add_u32 s41, s41, 8388608
    s_movk_i32 s43, 3456
    v_mul_lo_u32 v22, v20, s43
    v_lshlrev_b32 v23, 1, v21
    v_add_u32 v22, v22, v23
    s_mov_b32 s44, 0xbfb8aa3b
    s_mov_b32 s45, 0xffff0000
    v_add_u32 v24, 0, v22
    v_cvt_pk_bf16_f32 v131, v32, v33
    v_cvt_pk_bf16_f32 v132, v80, v81
    v_lshlrev_b32 v133, 16, v131
    v_and_b32 v134, s45, v131
    v_mul_f32 v135, s44, v133
    v_mul_f32 v136, s44, v134
    v_exp_f32 v135, v135
    v_exp_f32 v136, v136
    s_nop 0
    v_add_f32 v135, 1.0, v135
    v_add_f32 v136, 1.0, v136
    v_rcp_f32 v135, v135
    v_rcp_f32 v136, v136
    s_nop 0
    v_mul_f32 v133, v133, v135
    v_mul_f32 v134, v134, v136
    v_cvt_pk_bf16_f32 v131, v133, v134
    v_lshlrev_b32 v133, 16, v131
    v_and_b32 v134, s45, v131
    v_lshlrev_b32 v135, 16, v132
    v_and_b32 v136, s45, v132
    v_mul_f32 v133, v133, v135
    v_mul_f32 v134, v134, v136
    v_cvt_pk_bf16_f32 v128, v133, v134
    v_cvt_pk_bf16_f32 v139, v34, v35
    v_cvt_pk_bf16_f32 v140, v82, v83
    v_lshlrev_b32 v141, 16, v139
    v_and_b32 v142, s45, v139
    v_mul_f32 v143, s44, v141
    v_mul_f32 v144, s44, v142
    v_exp_f32 v143, v143
    v_exp_f32 v144, v144
    s_nop 0
    v_add_f32 v143, 1.0, v143
    v_add_f32 v144, 1.0, v144
    v_rcp_f32 v143, v143
    v_rcp_f32 v144, v144
    s_nop 0
    v_mul_f32 v141, v141, v143
    v_mul_f32 v142, v142, v144
    v_cvt_pk_bf16_f32 v139, v141, v142
    v_lshlrev_b32 v141, 16, v139
    v_and_b32 v142, s45, v139
    v_lshlrev_b32 v143, 16, v140
    v_and_b32 v144, s45, v140
    v_mul_f32 v141, v141, v143
    v_mul_f32 v142, v142, v144
    v_cvt_pk_bf16_f32 v129, v141, v142
    buffer_store_dwordx2 v[128:129], v24, s[24:27], s41 offen offset:0
    s_nop 1
    v_cvt_pk_bf16_f32 v131, v48, v49
    v_cvt_pk_bf16_f32 v132, v96, v97
    v_lshlrev_b32 v133, 16, v131
    v_and_b32 v134, s45, v131
    v_mul_f32 v135, s44, v133
    v_mul_f32 v136, s44, v134
    v_exp_f32 v135, v135
    v_exp_f32 v136, v136
    s_nop 0
    v_add_f32 v135, 1.0, v135
    v_add_f32 v136, 1.0, v136
    v_rcp_f32 v135, v135
    v_rcp_f32 v136, v136
    s_nop 0
    v_mul_f32 v133, v133, v135
    v_mul_f32 v134, v134, v136
    v_cvt_pk_bf16_f32 v131, v133, v134
    v_lshlrev_b32 v133, 16, v131
    v_and_b32 v134, s45, v131
    v_lshlrev_b32 v135, 16, v132
    v_and_b32 v136, s45, v132
    v_mul_f32 v133, v133, v135
    v_mul_f32 v134, v134, v136
    v_cvt_pk_bf16_f32 v128, v133, v134
    v_cvt_pk_bf16_f32 v139, v50, v51
    v_cvt_pk_bf16_f32 v140, v98, v99
    v_lshlrev_b32 v141, 16, v139
    v_and_b32 v142, s45, v139
    v_mul_f32 v143, s44, v141
    v_mul_f32 v144, s44, v142
    v_exp_f32 v143, v143
    v_exp_f32 v144, v144
    s_nop 0
    v_add_f32 v143, 1.0, v143
    v_add_f32 v144, 1.0, v144
    v_rcp_f32 v143, v143
    v_rcp_f32 v144, v144
    s_nop 0
    v_mul_f32 v141, v141, v143
    v_mul_f32 v142, v142, v144
    v_cvt_pk_bf16_f32 v139, v141, v142
    v_lshlrev_b32 v141, 16, v139
    v_and_b32 v142, s45, v139
    v_lshlrev_b32 v143, 16, v140
    v_and_b32 v144, s45, v140
    v_mul_f32 v141, v141, v143
    v_mul_f32 v142, v142, v144
    v_cvt_pk_bf16_f32 v129, v141, v142
    buffer_store_dwordx2 v[128:129], v24, s[24:27], s41 offen offset:32
    s_nop 1
    v_cvt_pk_bf16_f32 v131, v64, v65
    v_cvt_pk_bf16_f32 v132, v112, v113
    v_lshlrev_b32 v133, 16, v131
    v_and_b32 v134, s45, v131
    v_mul_f32 v135, s44, v133
    v_mul_f32 v136, s44, v134
    v_exp_f32 v135, v135
    v_exp_f32 v136, v136
    s_nop 0
    v_add_f32 v135, 1.0, v135
    v_add_f32 v136, 1.0, v136
    v_rcp_f32 v135, v135
    v_rcp_f32 v136, v136
    s_nop 0
    v_mul_f32 v133, v133, v135
    v_mul_f32 v134, v134, v136
    v_cvt_pk_bf16_f32 v131, v133, v134
    v_lshlrev_b32 v133, 16, v131
    v_and_b32 v134, s45, v131
    v_lshlrev_b32 v135, 16, v132
    v_and_b32 v136, s45, v132
    v_mul_f32 v133, v133, v135
    v_mul_f32 v134, v134, v136
    v_cvt_pk_bf16_f32 v128, v133, v134
    v_cvt_pk_bf16_f32 v139, v66, v67
    v_cvt_pk_bf16_f32 v140, v114, v115
    v_lshlrev_b32 v141, 16, v139
    v_and_b32 v142, s45, v139
    v_mul_f32 v143, s44, v141
    v_mul_f32 v144, s44, v142
    v_exp_f32 v143, v143
    v_exp_f32 v144, v144
    s_nop 0
    v_add_f32 v143, 1.0, v143
    v_add_f32 v144, 1.0, v144
    v_rcp_f32 v143, v143
    v_rcp_f32 v144, v144
    s_nop 0
    v_mul_f32 v141, v141, v143
    v_mul_f32 v142, v142, v144
    v_cvt_pk_bf16_f32 v139, v141, v142
    v_lshlrev_b32 v141, 16, v139
    v_and_b32 v142, s45, v139
    v_lshlrev_b32 v143, 16, v140
    v_and_b32 v144, s45, v140
    v_mul_f32 v141, v141, v143
    v_mul_f32 v142, v142, v144
    v_cvt_pk_bf16_f32 v129, v141, v142
    buffer_store_dwordx2 v[128:129], v24, s[24:27], s41 offen offset:64
    s_nop 1
    v_add_u32 v24, 55296, v22
    v_cvt_pk_bf16_f32 v131, v36, v37
    v_cvt_pk_bf16_f32 v132, v84, v85
    v_lshlrev_b32 v133, 16, v131
    v_and_b32 v134, s45, v131
    v_mul_f32 v135, s44, v133
    v_mul_f32 v136, s44, v134
    v_exp_f32 v135, v135
    v_exp_f32 v136, v136
    s_nop 0
    v_add_f32 v135, 1.0, v135
    v_add_f32 v136, 1.0, v136
    v_rcp_f32 v135, v135
    v_rcp_f32 v136, v136
    s_nop 0
    v_mul_f32 v133, v133, v135
    v_mul_f32 v134, v134, v136
    v_cvt_pk_bf16_f32 v131, v133, v134
    v_lshlrev_b32 v133, 16, v131
    v_and_b32 v134, s45, v131
    v_lshlrev_b32 v135, 16, v132
    v_and_b32 v136, s45, v132
    v_mul_f32 v133, v133, v135
    v_mul_f32 v134, v134, v136
    v_cvt_pk_bf16_f32 v128, v133, v134
    v_cvt_pk_bf16_f32 v139, v38, v39
    v_cvt_pk_bf16_f32 v140, v86, v87
    v_lshlrev_b32 v141, 16, v139
    v_and_b32 v142, s45, v139
    v_mul_f32 v143, s44, v141
    v_mul_f32 v144, s44, v142
    v_exp_f32 v143, v143
    v_exp_f32 v144, v144
    s_nop 0
    v_add_f32 v143, 1.0, v143
    v_add_f32 v144, 1.0, v144
    v_rcp_f32 v143, v143
    v_rcp_f32 v144, v144
    s_nop 0
    v_mul_f32 v141, v141, v143
    v_mul_f32 v142, v142, v144
    v_cvt_pk_bf16_f32 v139, v141, v142
    v_lshlrev_b32 v141, 16, v139
    v_and_b32 v142, s45, v139
    v_lshlrev_b32 v143, 16, v140
    v_and_b32 v144, s45, v140
    v_mul_f32 v141, v141, v143
    v_mul_f32 v142, v142, v144
    v_cvt_pk_bf16_f32 v129, v141, v142
    buffer_store_dwordx2 v[128:129], v24, s[24:27], s41 offen offset:0
    s_nop 1
    v_cvt_pk_bf16_f32 v131, v52, v53
    v_cvt_pk_bf16_f32 v132, v100, v101
    v_lshlrev_b32 v133, 16, v131
    v_and_b32 v134, s45, v131
    v_mul_f32 v135, s44, v133
    v_mul_f32 v136, s44, v134
    v_exp_f32 v135, v135
    v_exp_f32 v136, v136
    s_nop 0
    v_add_f32 v135, 1.0, v135
    v_add_f32 v136, 1.0, v136
    v_rcp_f32 v135, v135
    v_rcp_f32 v136, v136
    s_nop 0
    v_mul_f32 v133, v133, v135
    v_mul_f32 v134, v134, v136
    v_cvt_pk_bf16_f32 v131, v133, v134
    v_lshlrev_b32 v133, 16, v131
    v_and_b32 v134, s45, v131
    v_lshlrev_b32 v135, 16, v132
    v_and_b32 v136, s45, v132
    v_mul_f32 v133, v133, v135
    v_mul_f32 v134, v134, v136
    v_cvt_pk_bf16_f32 v128, v133, v134
    v_cvt_pk_bf16_f32 v139, v54, v55
    v_cvt_pk_bf16_f32 v140, v102, v103
    v_lshlrev_b32 v141, 16, v139
    v_and_b32 v142, s45, v139
    v_mul_f32 v143, s44, v141
    v_mul_f32 v144, s44, v142
    v_exp_f32 v143, v143
    v_exp_f32 v144, v144
    s_nop 0
    v_add_f32 v143, 1.0, v143
    v_add_f32 v144, 1.0, v144
    v_rcp_f32 v143, v143
    v_rcp_f32 v144, v144
    s_nop 0
    v_mul_f32 v141, v141, v143
    v_mul_f32 v142, v142, v144
    v_cvt_pk_bf16_f32 v139, v141, v142
    v_lshlrev_b32 v141, 16, v139
    v_and_b32 v142, s45, v139
    v_lshlrev_b32 v143, 16, v140
    v_and_b32 v144, s45, v140
    v_mul_f32 v141, v141, v143
    v_mul_f32 v142, v142, v144
    v_cvt_pk_bf16_f32 v129, v141, v142
    buffer_store_dwordx2 v[128:129], v24, s[24:27], s41 offen offset:32
    s_nop 1
    v_cvt_pk_bf16_f32 v131, v68, v69
    v_cvt_pk_bf16_f32 v132, v116, v117
    v_lshlrev_b32 v133, 16, v131
    v_and_b32 v134, s45, v131
    v_mul_f32 v135, s44, v133
    v_mul_f32 v136, s44, v134
    v_exp_f32 v135, v135
    v_exp_f32 v136, v136
    s_nop 0
    v_add_f32 v135, 1.0, v135
    v_add_f32 v136, 1.0, v136
    v_rcp_f32 v135, v135
    v_rcp_f32 v136, v136
    s_nop 0
    v_mul_f32 v133, v133, v135
    v_mul_f32 v134, v134, v136
    v_cvt_pk_bf16_f32 v131, v133, v134
    v_lshlrev_b32 v133, 16, v131
    v_and_b32 v134, s45, v131
    v_lshlrev_b32 v135, 16, v132
    v_and_b32 v136, s45, v132
    v_mul_f32 v133, v133, v135
    v_mul_f32 v134, v134, v136
    v_cvt_pk_bf16_f32 v128, v133, v134
    v_cvt_pk_bf16_f32 v139, v70, v71
    v_cvt_pk_bf16_f32 v140, v118, v119
    v_lshlrev_b32 v141, 16, v139
    v_and_b32 v142, s45, v139
    v_mul_f32 v143, s44, v141
    v_mul_f32 v144, s44, v142
    v_exp_f32 v143, v143
    v_exp_f32 v144, v144
    s_nop 0
    v_add_f32 v143, 1.0, v143
    v_add_f32 v144, 1.0, v144
    v_rcp_f32 v143, v143
    v_rcp_f32 v144, v144
    s_nop 0
    v_mul_f32 v141, v141, v143
    v_mul_f32 v142, v142, v144
    v_cvt_pk_bf16_f32 v139, v141, v142
    v_lshlrev_b32 v141, 16, v139
    v_and_b32 v142, s45, v139
    v_lshlrev_b32 v143, 16, v140
    v_and_b32 v144, s45, v140
    v_mul_f32 v141, v141, v143
    v_mul_f32 v142, v142, v144
    v_cvt_pk_bf16_f32 v129, v141, v142
    buffer_store_dwordx2 v[128:129], v24, s[24:27], s41 offen offset:64
    s_nop 1
    v_add_u32 v24, 110592, v22
    v_cvt_pk_bf16_f32 v131, v40, v41
    v_cvt_pk_bf16_f32 v132, v88, v89
    v_lshlrev_b32 v133, 16, v131
    v_and_b32 v134, s45, v131
    v_mul_f32 v135, s44, v133
    v_mul_f32 v136, s44, v134
    v_exp_f32 v135, v135
    v_exp_f32 v136, v136
    s_nop 0
    v_add_f32 v135, 1.0, v135
    v_add_f32 v136, 1.0, v136
    v_rcp_f32 v135, v135
    v_rcp_f32 v136, v136
    s_nop 0
    v_mul_f32 v133, v133, v135
    v_mul_f32 v134, v134, v136
    v_cvt_pk_bf16_f32 v131, v133, v134
    v_lshlrev_b32 v133, 16, v131
    v_and_b32 v134, s45, v131
    v_lshlrev_b32 v135, 16, v132
    v_and_b32 v136, s45, v132
    v_mul_f32 v133, v133, v135
    v_mul_f32 v134, v134, v136
    v_cvt_pk_bf16_f32 v128, v133, v134
    v_cvt_pk_bf16_f32 v139, v42, v43
    v_cvt_pk_bf16_f32 v140, v90, v91
    v_lshlrev_b32 v141, 16, v139
    v_and_b32 v142, s45, v139
    v_mul_f32 v143, s44, v141
    v_mul_f32 v144, s44, v142
    v_exp_f32 v143, v143
    v_exp_f32 v144, v144
    s_nop 0
    v_add_f32 v143, 1.0, v143
    v_add_f32 v144, 1.0, v144
    v_rcp_f32 v143, v143
    v_rcp_f32 v144, v144
    s_nop 0
    v_mul_f32 v141, v141, v143
    v_mul_f32 v142, v142, v144
    v_cvt_pk_bf16_f32 v139, v141, v142
    v_lshlrev_b32 v141, 16, v139
    v_and_b32 v142, s45, v139
    v_lshlrev_b32 v143, 16, v140
    v_and_b32 v144, s45, v140
    v_mul_f32 v141, v141, v143
    v_mul_f32 v142, v142, v144
    v_cvt_pk_bf16_f32 v129, v141, v142
    buffer_store_dwordx2 v[128:129], v24, s[24:27], s41 offen offset:0
    s_nop 1
    v_cvt_pk_bf16_f32 v131, v56, v57
    v_cvt_pk_bf16_f32 v132, v104, v105
    v_lshlrev_b32 v133, 16, v131
    v_and_b32 v134, s45, v131
    v_mul_f32 v135, s44, v133
    v_mul_f32 v136, s44, v134
    v_exp_f32 v135, v135
    v_exp_f32 v136, v136
    s_nop 0
    v_add_f32 v135, 1.0, v135
    v_add_f32 v136, 1.0, v136
    v_rcp_f32 v135, v135
    v_rcp_f32 v136, v136
    s_nop 0
    v_mul_f32 v133, v133, v135
    v_mul_f32 v134, v134, v136
    v_cvt_pk_bf16_f32 v131, v133, v134
    v_lshlrev_b32 v133, 16, v131
    v_and_b32 v134, s45, v131
    v_lshlrev_b32 v135, 16, v132
    v_and_b32 v136, s45, v132
    v_mul_f32 v133, v133, v135
    v_mul_f32 v134, v134, v136
    v_cvt_pk_bf16_f32 v128, v133, v134
    v_cvt_pk_bf16_f32 v139, v58, v59
    v_cvt_pk_bf16_f32 v140, v106, v107
    v_lshlrev_b32 v141, 16, v139
    v_and_b32 v142, s45, v139
    v_mul_f32 v143, s44, v141
    v_mul_f32 v144, s44, v142
    v_exp_f32 v143, v143
    v_exp_f32 v144, v144
    s_nop 0
    v_add_f32 v143, 1.0, v143
    v_add_f32 v144, 1.0, v144
    v_rcp_f32 v143, v143
    v_rcp_f32 v144, v144
    s_nop 0
    v_mul_f32 v141, v141, v143
    v_mul_f32 v142, v142, v144
    v_cvt_pk_bf16_f32 v139, v141, v142
    v_lshlrev_b32 v141, 16, v139
    v_and_b32 v142, s45, v139
    v_lshlrev_b32 v143, 16, v140
    v_and_b32 v144, s45, v140
    v_mul_f32 v141, v141, v143
    v_mul_f32 v142, v142, v144
    v_cvt_pk_bf16_f32 v129, v141, v142
    buffer_store_dwordx2 v[128:129], v24, s[24:27], s41 offen offset:32
    s_nop 1
    v_cvt_pk_bf16_f32 v131, v72, v73
    v_cvt_pk_bf16_f32 v132, v120, v121
    v_lshlrev_b32 v133, 16, v131
    v_and_b32 v134, s45, v131
    v_mul_f32 v135, s44, v133
    v_mul_f32 v136, s44, v134
    v_exp_f32 v135, v135
    v_exp_f32 v136, v136
    s_nop 0
    v_add_f32 v135, 1.0, v135
    v_add_f32 v136, 1.0, v136
    v_rcp_f32 v135, v135
    v_rcp_f32 v136, v136
    s_nop 0
    v_mul_f32 v133, v133, v135
    v_mul_f32 v134, v134, v136
    v_cvt_pk_bf16_f32 v131, v133, v134
    v_lshlrev_b32 v133, 16, v131
    v_and_b32 v134, s45, v131
    v_lshlrev_b32 v135, 16, v132
    v_and_b32 v136, s45, v132
    v_mul_f32 v133, v133, v135
    v_mul_f32 v134, v134, v136
    v_cvt_pk_bf16_f32 v128, v133, v134
    v_cvt_pk_bf16_f32 v139, v74, v75
    v_cvt_pk_bf16_f32 v140, v122, v123
    v_lshlrev_b32 v141, 16, v139
    v_and_b32 v142, s45, v139
    v_mul_f32 v143, s44, v141
    v_mul_f32 v144, s44, v142
    v_exp_f32 v143, v143
    v_exp_f32 v144, v144
    s_nop 0
    v_add_f32 v143, 1.0, v143
    v_add_f32 v144, 1.0, v144
    v_rcp_f32 v143, v143
    v_rcp_f32 v144, v144
    s_nop 0
    v_mul_f32 v141, v141, v143
    v_mul_f32 v142, v142, v144
    v_cvt_pk_bf16_f32 v139, v141, v142
    v_lshlrev_b32 v141, 16, v139
    v_and_b32 v142, s45, v139
    v_lshlrev_b32 v143, 16, v140
    v_and_b32 v144, s45, v140
    v_mul_f32 v141, v141, v143
    v_mul_f32 v142, v142, v144
    v_cvt_pk_bf16_f32 v129, v141, v142
    buffer_store_dwordx2 v[128:129], v24, s[24:27], s41 offen offset:64
    s_nop 1
    v_add_u32 v24, 165888, v22
    v_cvt_pk_bf16_f32 v131, v44, v45
    v_cvt_pk_bf16_f32 v132, v92, v93
    v_lshlrev_b32 v133, 16, v131
    v_and_b32 v134, s45, v131
    v_mul_f32 v135, s44, v133
    v_mul_f32 v136, s44, v134
    v_exp_f32 v135, v135
    v_exp_f32 v136, v136
    s_nop 0
    v_add_f32 v135, 1.0, v135
    v_add_f32 v136, 1.0, v136
    v_rcp_f32 v135, v135
    v_rcp_f32 v136, v136
    s_nop 0
    v_mul_f32 v133, v133, v135
    v_mul_f32 v134, v134, v136
    v_cvt_pk_bf16_f32 v131, v133, v134
    v_lshlrev_b32 v133, 16, v131
    v_and_b32 v134, s45, v131
    v_lshlrev_b32 v135, 16, v132
    v_and_b32 v136, s45, v132
    v_mul_f32 v133, v133, v135
    v_mul_f32 v134, v134, v136
    v_cvt_pk_bf16_f32 v128, v133, v134
    v_cvt_pk_bf16_f32 v139, v46, v47
    v_cvt_pk_bf16_f32 v140, v94, v95
    v_lshlrev_b32 v141, 16, v139
    v_and_b32 v142, s45, v139
    v_mul_f32 v143, s44, v141
    v_mul_f32 v144, s44, v142
    v_exp_f32 v143, v143
    v_exp_f32 v144, v144
    s_nop 0
    v_add_f32 v143, 1.0, v143
    v_add_f32 v144, 1.0, v144
    v_rcp_f32 v143, v143
    v_rcp_f32 v144, v144
    s_nop 0
    v_mul_f32 v141, v141, v143
    v_mul_f32 v142, v142, v144
    v_cvt_pk_bf16_f32 v139, v141, v142
    v_lshlrev_b32 v141, 16, v139
    v_and_b32 v142, s45, v139
    v_lshlrev_b32 v143, 16, v140
    v_and_b32 v144, s45, v140
    v_mul_f32 v141, v141, v143
    v_mul_f32 v142, v142, v144
    v_cvt_pk_bf16_f32 v129, v141, v142
    buffer_store_dwordx2 v[128:129], v24, s[24:27], s41 offen offset:0
    s_nop 1
    v_cvt_pk_bf16_f32 v131, v60, v61
    v_cvt_pk_bf16_f32 v132, v108, v109
    v_lshlrev_b32 v133, 16, v131
    v_and_b32 v134, s45, v131
    v_mul_f32 v135, s44, v133
    v_mul_f32 v136, s44, v134
    v_exp_f32 v135, v135
    v_exp_f32 v136, v136
    s_nop 0
    v_add_f32 v135, 1.0, v135
    v_add_f32 v136, 1.0, v136
    v_rcp_f32 v135, v135
    v_rcp_f32 v136, v136
    s_nop 0
    v_mul_f32 v133, v133, v135
    v_mul_f32 v134, v134, v136
    v_cvt_pk_bf16_f32 v131, v133, v134
    v_lshlrev_b32 v133, 16, v131
    v_and_b32 v134, s45, v131
    v_lshlrev_b32 v135, 16, v132
    v_and_b32 v136, s45, v132
    v_mul_f32 v133, v133, v135
    v_mul_f32 v134, v134, v136
    v_cvt_pk_bf16_f32 v128, v133, v134
    v_cvt_pk_bf16_f32 v139, v62, v63
    v_cvt_pk_bf16_f32 v140, v110, v111
    v_lshlrev_b32 v141, 16, v139
    v_and_b32 v142, s45, v139
    v_mul_f32 v143, s44, v141
    v_mul_f32 v144, s44, v142
    v_exp_f32 v143, v143
    v_exp_f32 v144, v144
    s_nop 0
    v_add_f32 v143, 1.0, v143
    v_add_f32 v144, 1.0, v144
    v_rcp_f32 v143, v143
    v_rcp_f32 v144, v144
    s_nop 0
    v_mul_f32 v141, v141, v143
    v_mul_f32 v142, v142, v144
    v_cvt_pk_bf16_f32 v139, v141, v142
    v_lshlrev_b32 v141, 16, v139
    v_and_b32 v142, s45, v139
    v_lshlrev_b32 v143, 16, v140
    v_and_b32 v144, s45, v140
    v_mul_f32 v141, v141, v143
    v_mul_f32 v142, v142, v144
    v_cvt_pk_bf16_f32 v129, v141, v142
    buffer_store_dwordx2 v[128:129], v24, s[24:27], s41 offen offset:32
    s_nop 1
    v_cvt_pk_bf16_f32 v131, v76, v77
    v_cvt_pk_bf16_f32 v132, v124, v125
    v_lshlrev_b32 v133, 16, v131
    v_and_b32 v134, s45, v131
    v_mul_f32 v135, s44, v133
    v_mul_f32 v136, s44, v134
    v_exp_f32 v135, v135
    v_exp_f32 v136, v136
    s_nop 0
    v_add_f32 v135, 1.0, v135
    v_add_f32 v136, 1.0, v136
    v_rcp_f32 v135, v135
    v_rcp_f32 v136, v136
    s_nop 0
    v_mul_f32 v133, v133, v135
    v_mul_f32 v134, v134, v136
    v_cvt_pk_bf16_f32 v131, v133, v134
    v_lshlrev_b32 v133, 16, v131
    v_and_b32 v134, s45, v131
    v_lshlrev_b32 v135, 16, v132
    v_and_b32 v136, s45, v132
    v_mul_f32 v133, v133, v135
    v_mul_f32 v134, v134, v136
    v_cvt_pk_bf16_f32 v128, v133, v134
    v_cvt_pk_bf16_f32 v139, v78, v79
    v_cvt_pk_bf16_f32 v140, v126, v127
    v_lshlrev_b32 v141, 16, v139
    v_and_b32 v142, s45, v139
    v_mul_f32 v143, s44, v141
    v_mul_f32 v144, s44, v142
    v_exp_f32 v143, v143
    v_exp_f32 v144, v144
    s_nop 0
    v_add_f32 v143, 1.0, v143
    v_add_f32 v144, 1.0, v144
    v_rcp_f32 v143, v143
    v_rcp_f32 v144, v144
    s_nop 0
    v_mul_f32 v141, v141, v143
    v_mul_f32 v142, v142, v144
    v_cvt_pk_bf16_f32 v139, v141, v142
    v_lshlrev_b32 v141, 16, v139
    v_and_b32 v142, s45, v139
    v_lshlrev_b32 v143, 16, v140
    v_and_b32 v144, s45, v140
    v_mul_f32 v141, v141, v143
    v_mul_f32 v142, v142, v144
    v_cvt_pk_bf16_f32 v129, v141, v142
    buffer_store_dwordx2 v[128:129], v24, s[24:27], s41 offen offset:64
    s_nop 1
    k1_kernel_end:
    s_endpgm
    k1_kernel_gate:
    s_cmp_ge_u32 s2, 256
    s_cbranch_scc1 k1_kernel_end
    s_load_dwordx2 s[4:5], s[0:1], 0
    s_load_dwordx2 s[6:7], s[0:1], 56
    s_load_dwordx2 s[12:13], s[0:1], 80
    v_lshrrev_b32 v2, 3, v0
    v_and_b32 v3, 7, v0
    s_sub_u32 s28, s2, 224
    s_lshl_b32 s28, s28, 6
    v_add_u32 v2, s28, v2
    v_mul_u32_u24 v4, 1280, v2
    v_mul_u32_u24 v5, 160, v3
    v_add_u32 v4, v4, v5
    s_waitcnt lgkmcnt(0)
    s_mov_b32 s16, s4
    s_and_b32 s17, s5, 0xffff
    s_mov_b32 s18, 2621440
    s_mov_b32 s19, 0x00020000
    s_mov_b32 s20, s6
    s_and_b32 s21, s7, 0xffff
    s_mov_b32 s22, 1280
    s_mov_b32 s23, 0x00020000
    s_mov_b32 s24, s12
    s_and_b32 s25, s13, 0xffff
    s_mov_b32 s26, 25165824
    s_mov_b32 s27, 0x00020000
    s_mov_b32 s45, 0xffff0000
    buffer_load_dwordx4 v[32:35], v4, s[16:19], 0 offen offset:0
    buffer_load_dwordx4 v[80:83], v5, s[20:23], 0 offen offset:0
    buffer_load_dwordx4 v[36:39], v4, s[16:19], 0 offen offset:16
    buffer_load_dwordx4 v[84:87], v5, s[20:23], 0 offen offset:16
    buffer_load_dwordx4 v[40:43], v4, s[16:19], 0 offen offset:32
    buffer_load_dwordx4 v[88:91], v5, s[20:23], 0 offen offset:32
    buffer_load_dwordx4 v[44:47], v4, s[16:19], 0 offen offset:48
    buffer_load_dwordx4 v[92:95], v5, s[20:23], 0 offen offset:48
    buffer_load_dwordx4 v[48:51], v4, s[16:19], 0 offen offset:64
    buffer_load_dwordx4 v[96:99], v5, s[20:23], 0 offen offset:64
    buffer_load_dwordx4 v[52:55], v4, s[16:19], 0 offen offset:80
    buffer_load_dwordx4 v[100:103], v5, s[20:23], 0 offen offset:80
    buffer_load_dwordx4 v[56:59], v4, s[16:19], 0 offen offset:96
    buffer_load_dwordx4 v[104:107], v5, s[20:23], 0 offen offset:96
    buffer_load_dwordx4 v[60:63], v4, s[16:19], 0 offen offset:112
    buffer_load_dwordx4 v[108:111], v5, s[20:23], 0 offen offset:112
    buffer_load_dwordx4 v[64:67], v4, s[16:19], 0 offen offset:128
    buffer_load_dwordx4 v[112:115], v5, s[20:23], 0 offen offset:128
    buffer_load_dwordx4 v[68:71], v4, s[16:19], 0 offen offset:144
    buffer_load_dwordx4 v[116:119], v5, s[20:23], 0 offen offset:144
    v_mov_b32 v6, 0
    v_mov_b32 v7, 0
    s_waitcnt vmcnt(0)
    v_lshlrev_b32 v8, 16, v32
    v_and_b32 v9, s45, v32
    v_lshlrev_b32 v10, 16, v80
    v_and_b32 v11, s45, v80
    v_mul_f32 v8, v8, v10
    v_mul_f32 v9, v9, v11
    v_cvt_pk_bf16_f32 v8, v8, v9
    v_lshlrev_b32 v9, 16, v8
    v_and_b32 v8, s45, v8
    v_add_f32 v6, v6, v9
    v_add_f32 v7, v7, v8
    v_lshlrev_b32 v8, 16, v33
    v_and_b32 v9, s45, v33
    v_lshlrev_b32 v10, 16, v81
    v_and_b32 v11, s45, v81
    v_mul_f32 v8, v8, v10
    v_mul_f32 v9, v9, v11
    v_cvt_pk_bf16_f32 v8, v8, v9
    v_lshlrev_b32 v9, 16, v8
    v_and_b32 v8, s45, v8
    v_add_f32 v6, v6, v9
    v_add_f32 v7, v7, v8
    v_lshlrev_b32 v8, 16, v34
    v_and_b32 v9, s45, v34
    v_lshlrev_b32 v10, 16, v82
    v_and_b32 v11, s45, v82
    v_mul_f32 v8, v8, v10
    v_mul_f32 v9, v9, v11
    v_cvt_pk_bf16_f32 v8, v8, v9
    v_lshlrev_b32 v9, 16, v8
    v_and_b32 v8, s45, v8
    v_add_f32 v6, v6, v9
    v_add_f32 v7, v7, v8
    v_lshlrev_b32 v8, 16, v35
    v_and_b32 v9, s45, v35
    v_lshlrev_b32 v10, 16, v83
    v_and_b32 v11, s45, v83
    v_mul_f32 v8, v8, v10
    v_mul_f32 v9, v9, v11
    v_cvt_pk_bf16_f32 v8, v8, v9
    v_lshlrev_b32 v9, 16, v8
    v_and_b32 v8, s45, v8
    v_add_f32 v6, v6, v9
    v_add_f32 v7, v7, v8
    v_lshlrev_b32 v8, 16, v36
    v_and_b32 v9, s45, v36
    v_lshlrev_b32 v10, 16, v84
    v_and_b32 v11, s45, v84
    v_mul_f32 v8, v8, v10
    v_mul_f32 v9, v9, v11
    v_cvt_pk_bf16_f32 v8, v8, v9
    v_lshlrev_b32 v9, 16, v8
    v_and_b32 v8, s45, v8
    v_add_f32 v6, v6, v9
    v_add_f32 v7, v7, v8
    v_lshlrev_b32 v8, 16, v37
    v_and_b32 v9, s45, v37
    v_lshlrev_b32 v10, 16, v85
    v_and_b32 v11, s45, v85
    v_mul_f32 v8, v8, v10
    v_mul_f32 v9, v9, v11
    v_cvt_pk_bf16_f32 v8, v8, v9
    v_lshlrev_b32 v9, 16, v8
    v_and_b32 v8, s45, v8
    v_add_f32 v6, v6, v9
    v_add_f32 v7, v7, v8
    v_lshlrev_b32 v8, 16, v38
    v_and_b32 v9, s45, v38
    v_lshlrev_b32 v10, 16, v86
    v_and_b32 v11, s45, v86
    v_mul_f32 v8, v8, v10
    v_mul_f32 v9, v9, v11
    v_cvt_pk_bf16_f32 v8, v8, v9
    v_lshlrev_b32 v9, 16, v8
    v_and_b32 v8, s45, v8
    v_add_f32 v6, v6, v9
    v_add_f32 v7, v7, v8
    v_lshlrev_b32 v8, 16, v39
    v_and_b32 v9, s45, v39
    v_lshlrev_b32 v10, 16, v87
    v_and_b32 v11, s45, v87
    v_mul_f32 v8, v8, v10
    v_mul_f32 v9, v9, v11
    v_cvt_pk_bf16_f32 v8, v8, v9
    v_lshlrev_b32 v9, 16, v8
    v_and_b32 v8, s45, v8
    v_add_f32 v6, v6, v9
    v_add_f32 v7, v7, v8
    v_lshlrev_b32 v8, 16, v40
    v_and_b32 v9, s45, v40
    v_lshlrev_b32 v10, 16, v88
    v_and_b32 v11, s45, v88
    v_mul_f32 v8, v8, v10
    v_mul_f32 v9, v9, v11
    v_cvt_pk_bf16_f32 v8, v8, v9
    v_lshlrev_b32 v9, 16, v8
    v_and_b32 v8, s45, v8
    v_add_f32 v6, v6, v9
    v_add_f32 v7, v7, v8
    v_lshlrev_b32 v8, 16, v41
    v_and_b32 v9, s45, v41
    v_lshlrev_b32 v10, 16, v89
    v_and_b32 v11, s45, v89
    v_mul_f32 v8, v8, v10
    v_mul_f32 v9, v9, v11
    v_cvt_pk_bf16_f32 v8, v8, v9
    v_lshlrev_b32 v9, 16, v8
    v_and_b32 v8, s45, v8
    v_add_f32 v6, v6, v9
    v_add_f32 v7, v7, v8
    v_lshlrev_b32 v8, 16, v42
    v_and_b32 v9, s45, v42
    v_lshlrev_b32 v10, 16, v90
    v_and_b32 v11, s45, v90
    v_mul_f32 v8, v8, v10
    v_mul_f32 v9, v9, v11
    v_cvt_pk_bf16_f32 v8, v8, v9
    v_lshlrev_b32 v9, 16, v8
    v_and_b32 v8, s45, v8
    v_add_f32 v6, v6, v9
    v_add_f32 v7, v7, v8
    v_lshlrev_b32 v8, 16, v43
    v_and_b32 v9, s45, v43
    v_lshlrev_b32 v10, 16, v91
    v_and_b32 v11, s45, v91
    v_mul_f32 v8, v8, v10
    v_mul_f32 v9, v9, v11
    v_cvt_pk_bf16_f32 v8, v8, v9
    v_lshlrev_b32 v9, 16, v8
    v_and_b32 v8, s45, v8
    v_add_f32 v6, v6, v9
    v_add_f32 v7, v7, v8
    v_lshlrev_b32 v8, 16, v44
    v_and_b32 v9, s45, v44
    v_lshlrev_b32 v10, 16, v92
    v_and_b32 v11, s45, v92
    v_mul_f32 v8, v8, v10
    v_mul_f32 v9, v9, v11
    v_cvt_pk_bf16_f32 v8, v8, v9
    v_lshlrev_b32 v9, 16, v8
    v_and_b32 v8, s45, v8
    v_add_f32 v6, v6, v9
    v_add_f32 v7, v7, v8
    v_lshlrev_b32 v8, 16, v45
    v_and_b32 v9, s45, v45
    v_lshlrev_b32 v10, 16, v93
    v_and_b32 v11, s45, v93
    v_mul_f32 v8, v8, v10
    v_mul_f32 v9, v9, v11
    v_cvt_pk_bf16_f32 v8, v8, v9
    v_lshlrev_b32 v9, 16, v8
    v_and_b32 v8, s45, v8
    v_add_f32 v6, v6, v9
    v_add_f32 v7, v7, v8
    v_lshlrev_b32 v8, 16, v46
    v_and_b32 v9, s45, v46
    v_lshlrev_b32 v10, 16, v94
    v_and_b32 v11, s45, v94
    v_mul_f32 v8, v8, v10
    v_mul_f32 v9, v9, v11
    v_cvt_pk_bf16_f32 v8, v8, v9
    v_lshlrev_b32 v9, 16, v8
    v_and_b32 v8, s45, v8
    v_add_f32 v6, v6, v9
    v_add_f32 v7, v7, v8
    v_lshlrev_b32 v8, 16, v47
    v_and_b32 v9, s45, v47
    v_lshlrev_b32 v10, 16, v95
    v_and_b32 v11, s45, v95
    v_mul_f32 v8, v8, v10
    v_mul_f32 v9, v9, v11
    v_cvt_pk_bf16_f32 v8, v8, v9
    v_lshlrev_b32 v9, 16, v8
    v_and_b32 v8, s45, v8
    v_add_f32 v6, v6, v9
    v_add_f32 v7, v7, v8
    v_lshlrev_b32 v8, 16, v48
    v_and_b32 v9, s45, v48
    v_lshlrev_b32 v10, 16, v96
    v_and_b32 v11, s45, v96
    v_mul_f32 v8, v8, v10
    v_mul_f32 v9, v9, v11
    v_cvt_pk_bf16_f32 v8, v8, v9
    v_lshlrev_b32 v9, 16, v8
    v_and_b32 v8, s45, v8
    v_add_f32 v6, v6, v9
    v_add_f32 v7, v7, v8
    v_lshlrev_b32 v8, 16, v49
    v_and_b32 v9, s45, v49
    v_lshlrev_b32 v10, 16, v97
    v_and_b32 v11, s45, v97
    v_mul_f32 v8, v8, v10
    v_mul_f32 v9, v9, v11
    v_cvt_pk_bf16_f32 v8, v8, v9
    v_lshlrev_b32 v9, 16, v8
    v_and_b32 v8, s45, v8
    v_add_f32 v6, v6, v9
    v_add_f32 v7, v7, v8
    v_lshlrev_b32 v8, 16, v50
    v_and_b32 v9, s45, v50
    v_lshlrev_b32 v10, 16, v98
    v_and_b32 v11, s45, v98
    v_mul_f32 v8, v8, v10
    v_mul_f32 v9, v9, v11
    v_cvt_pk_bf16_f32 v8, v8, v9
    v_lshlrev_b32 v9, 16, v8
    v_and_b32 v8, s45, v8
    v_add_f32 v6, v6, v9
    v_add_f32 v7, v7, v8
    v_lshlrev_b32 v8, 16, v51
    v_and_b32 v9, s45, v51
    v_lshlrev_b32 v10, 16, v99
    v_and_b32 v11, s45, v99
    v_mul_f32 v8, v8, v10
    v_mul_f32 v9, v9, v11
    v_cvt_pk_bf16_f32 v8, v8, v9
    v_lshlrev_b32 v9, 16, v8
    v_and_b32 v8, s45, v8
    v_add_f32 v6, v6, v9
    v_add_f32 v7, v7, v8
    v_lshlrev_b32 v8, 16, v52
    v_and_b32 v9, s45, v52
    v_lshlrev_b32 v10, 16, v100
    v_and_b32 v11, s45, v100
    v_mul_f32 v8, v8, v10
    v_mul_f32 v9, v9, v11
    v_cvt_pk_bf16_f32 v8, v8, v9
    v_lshlrev_b32 v9, 16, v8
    v_and_b32 v8, s45, v8
    v_add_f32 v6, v6, v9
    v_add_f32 v7, v7, v8
    v_lshlrev_b32 v8, 16, v53
    v_and_b32 v9, s45, v53
    v_lshlrev_b32 v10, 16, v101
    v_and_b32 v11, s45, v101
    v_mul_f32 v8, v8, v10
    v_mul_f32 v9, v9, v11
    v_cvt_pk_bf16_f32 v8, v8, v9
    v_lshlrev_b32 v9, 16, v8
    v_and_b32 v8, s45, v8
    v_add_f32 v6, v6, v9
    v_add_f32 v7, v7, v8
    v_lshlrev_b32 v8, 16, v54
    v_and_b32 v9, s45, v54
    v_lshlrev_b32 v10, 16, v102
    v_and_b32 v11, s45, v102
    v_mul_f32 v8, v8, v10
    v_mul_f32 v9, v9, v11
    v_cvt_pk_bf16_f32 v8, v8, v9
    v_lshlrev_b32 v9, 16, v8
    v_and_b32 v8, s45, v8
    v_add_f32 v6, v6, v9
    v_add_f32 v7, v7, v8
    v_lshlrev_b32 v8, 16, v55
    v_and_b32 v9, s45, v55
    v_lshlrev_b32 v10, 16, v103
    v_and_b32 v11, s45, v103
    v_mul_f32 v8, v8, v10
    v_mul_f32 v9, v9, v11
    v_cvt_pk_bf16_f32 v8, v8, v9
    v_lshlrev_b32 v9, 16, v8
    v_and_b32 v8, s45, v8
    v_add_f32 v6, v6, v9
    v_add_f32 v7, v7, v8
    v_lshlrev_b32 v8, 16, v56
    v_and_b32 v9, s45, v56
    v_lshlrev_b32 v10, 16, v104
    v_and_b32 v11, s45, v104
    v_mul_f32 v8, v8, v10
    v_mul_f32 v9, v9, v11
    v_cvt_pk_bf16_f32 v8, v8, v9
    v_lshlrev_b32 v9, 16, v8
    v_and_b32 v8, s45, v8
    v_add_f32 v6, v6, v9
    v_add_f32 v7, v7, v8
    v_lshlrev_b32 v8, 16, v57
    v_and_b32 v9, s45, v57
    v_lshlrev_b32 v10, 16, v105
    v_and_b32 v11, s45, v105
    v_mul_f32 v8, v8, v10
    v_mul_f32 v9, v9, v11
    v_cvt_pk_bf16_f32 v8, v8, v9
    v_lshlrev_b32 v9, 16, v8
    v_and_b32 v8, s45, v8
    v_add_f32 v6, v6, v9
    v_add_f32 v7, v7, v8
    v_lshlrev_b32 v8, 16, v58
    v_and_b32 v9, s45, v58
    v_lshlrev_b32 v10, 16, v106
    v_and_b32 v11, s45, v106
    v_mul_f32 v8, v8, v10
    v_mul_f32 v9, v9, v11
    v_cvt_pk_bf16_f32 v8, v8, v9
    v_lshlrev_b32 v9, 16, v8
    v_and_b32 v8, s45, v8
    v_add_f32 v6, v6, v9
    v_add_f32 v7, v7, v8
    v_lshlrev_b32 v8, 16, v59
    v_and_b32 v9, s45, v59
    v_lshlrev_b32 v10, 16, v107
    v_and_b32 v11, s45, v107
    v_mul_f32 v8, v8, v10
    v_mul_f32 v9, v9, v11
    v_cvt_pk_bf16_f32 v8, v8, v9
    v_lshlrev_b32 v9, 16, v8
    v_and_b32 v8, s45, v8
    v_add_f32 v6, v6, v9
    v_add_f32 v7, v7, v8
    v_lshlrev_b32 v8, 16, v60
    v_and_b32 v9, s45, v60
    v_lshlrev_b32 v10, 16, v108
    v_and_b32 v11, s45, v108
    v_mul_f32 v8, v8, v10
    v_mul_f32 v9, v9, v11
    v_cvt_pk_bf16_f32 v8, v8, v9
    v_lshlrev_b32 v9, 16, v8
    v_and_b32 v8, s45, v8
    v_add_f32 v6, v6, v9
    v_add_f32 v7, v7, v8
    v_lshlrev_b32 v8, 16, v61
    v_and_b32 v9, s45, v61
    v_lshlrev_b32 v10, 16, v109
    v_and_b32 v11, s45, v109
    v_mul_f32 v8, v8, v10
    v_mul_f32 v9, v9, v11
    v_cvt_pk_bf16_f32 v8, v8, v9
    v_lshlrev_b32 v9, 16, v8
    v_and_b32 v8, s45, v8
    v_add_f32 v6, v6, v9
    v_add_f32 v7, v7, v8
    v_lshlrev_b32 v8, 16, v62
    v_and_b32 v9, s45, v62
    v_lshlrev_b32 v10, 16, v110
    v_and_b32 v11, s45, v110
    v_mul_f32 v8, v8, v10
    v_mul_f32 v9, v9, v11
    v_cvt_pk_bf16_f32 v8, v8, v9
    v_lshlrev_b32 v9, 16, v8
    v_and_b32 v8, s45, v8
    v_add_f32 v6, v6, v9
    v_add_f32 v7, v7, v8
    v_lshlrev_b32 v8, 16, v63
    v_and_b32 v9, s45, v63
    v_lshlrev_b32 v10, 16, v111
    v_and_b32 v11, s45, v111
    v_mul_f32 v8, v8, v10
    v_mul_f32 v9, v9, v11
    v_cvt_pk_bf16_f32 v8, v8, v9
    v_lshlrev_b32 v9, 16, v8
    v_and_b32 v8, s45, v8
    v_add_f32 v6, v6, v9
    v_add_f32 v7, v7, v8
    v_lshlrev_b32 v8, 16, v64
    v_and_b32 v9, s45, v64
    v_lshlrev_b32 v10, 16, v112
    v_and_b32 v11, s45, v112
    v_mul_f32 v8, v8, v10
    v_mul_f32 v9, v9, v11
    v_cvt_pk_bf16_f32 v8, v8, v9
    v_lshlrev_b32 v9, 16, v8
    v_and_b32 v8, s45, v8
    v_add_f32 v6, v6, v9
    v_add_f32 v7, v7, v8
    v_lshlrev_b32 v8, 16, v65
    v_and_b32 v9, s45, v65
    v_lshlrev_b32 v10, 16, v113
    v_and_b32 v11, s45, v113
    v_mul_f32 v8, v8, v10
    v_mul_f32 v9, v9, v11
    v_cvt_pk_bf16_f32 v8, v8, v9
    v_lshlrev_b32 v9, 16, v8
    v_and_b32 v8, s45, v8
    v_add_f32 v6, v6, v9
    v_add_f32 v7, v7, v8
    v_lshlrev_b32 v8, 16, v66
    v_and_b32 v9, s45, v66
    v_lshlrev_b32 v10, 16, v114
    v_and_b32 v11, s45, v114
    v_mul_f32 v8, v8, v10
    v_mul_f32 v9, v9, v11
    v_cvt_pk_bf16_f32 v8, v8, v9
    v_lshlrev_b32 v9, 16, v8
    v_and_b32 v8, s45, v8
    v_add_f32 v6, v6, v9
    v_add_f32 v7, v7, v8
    v_lshlrev_b32 v8, 16, v67
    v_and_b32 v9, s45, v67
    v_lshlrev_b32 v10, 16, v115
    v_and_b32 v11, s45, v115
    v_mul_f32 v8, v8, v10
    v_mul_f32 v9, v9, v11
    v_cvt_pk_bf16_f32 v8, v8, v9
    v_lshlrev_b32 v9, 16, v8
    v_and_b32 v8, s45, v8
    v_add_f32 v6, v6, v9
    v_add_f32 v7, v7, v8
    v_lshlrev_b32 v8, 16, v68
    v_and_b32 v9, s45, v68
    v_lshlrev_b32 v10, 16, v116
    v_and_b32 v11, s45, v116
    v_mul_f32 v8, v8, v10
    v_mul_f32 v9, v9, v11
    v_cvt_pk_bf16_f32 v8, v8, v9
    v_lshlrev_b32 v9, 16, v8
    v_and_b32 v8, s45, v8
    v_add_f32 v6, v6, v9
    v_add_f32 v7, v7, v8
    v_lshlrev_b32 v8, 16, v69
    v_and_b32 v9, s45, v69
    v_lshlrev_b32 v10, 16, v117
    v_and_b32 v11, s45, v117
    v_mul_f32 v8, v8, v10
    v_mul_f32 v9, v9, v11
    v_cvt_pk_bf16_f32 v8, v8, v9
    v_lshlrev_b32 v9, 16, v8
    v_and_b32 v8, s45, v8
    v_add_f32 v6, v6, v9
    v_add_f32 v7, v7, v8
    v_lshlrev_b32 v8, 16, v70
    v_and_b32 v9, s45, v70
    v_lshlrev_b32 v10, 16, v118
    v_and_b32 v11, s45, v118
    v_mul_f32 v8, v8, v10
    v_mul_f32 v9, v9, v11
    v_cvt_pk_bf16_f32 v8, v8, v9
    v_lshlrev_b32 v9, 16, v8
    v_and_b32 v8, s45, v8
    v_add_f32 v6, v6, v9
    v_add_f32 v7, v7, v8
    v_lshlrev_b32 v8, 16, v71
    v_and_b32 v9, s45, v71
    v_lshlrev_b32 v10, 16, v119
    v_and_b32 v11, s45, v119
    v_mul_f32 v8, v8, v10
    v_mul_f32 v9, v9, v11
    v_cvt_pk_bf16_f32 v8, v8, v9
    v_lshlrev_b32 v9, 16, v8
    v_and_b32 v8, s45, v8
    v_add_f32 v6, v6, v9
    v_add_f32 v7, v7, v8
    v_add_f32 v6, v6, v7
    ds_swizzle_b32 v7, v6 offset:0x041F
    s_waitcnt lgkmcnt(0)
    v_add_f32 v6, v6, v7
    ds_swizzle_b32 v7, v6 offset:0x081F
    s_waitcnt lgkmcnt(0)
    v_add_f32 v6, v6, v7
    ds_swizzle_b32 v7, v6 offset:0x101F
    s_waitcnt lgkmcnt(0)
    v_add_f32 v6, v6, v7
    v_cvt_pk_bf16_f32 v6, v6, v6
    v_lshlrev_b32 v6, 16, v6
    v_mul_f32 v6, 0xbfb8aa3b, v6
    v_exp_f32 v6, v6
    s_nop 0
    v_add_f32 v6, 1.0, v6
    v_rcp_f32 v6, v6
    s_nop 0
    v_cvt_pk_bf16_f32 v6, v6, v6
    v_lshlrev_b32 v6, 16, v6
    v_lshlrev_b32 v2, 2, v2
    v_add_u32 v2, 20971520, v2
    v_cmp_eq_u32 vcc, 0, v3
    s_and_saveexec_b64 s[44:45], vcc
    buffer_store_dword v6, v2, s[24:27], 0 offen
    s_endpgm

.section .rodata,"a"
.p2align 6
.amdhsa_kernel k1_kernel
  .amdhsa_next_free_vgpr 208
  .amdhsa_next_free_sgpr 64
  .amdhsa_accum_offset 208
  .amdhsa_group_segment_fixed_size 0
  .amdhsa_kernarg_size 88
  .amdhsa_user_sgpr_count 2
  .amdhsa_user_sgpr_kernarg_segment_ptr 1
  .amdhsa_system_sgpr_workgroup_id_x 1
.end_amdhsa_kernel
.text
.globl k2_kernel
.p2align 8
.type k2_kernel,@function
k2_kernel:
    s_cmp_ge_u32 s2, 512
    s_cbranch_scc1 k2_kernel_end
    s_load_dwordx2 s[12:13], s[0:1], 80
    v_and_b32 v1, 63, v0
    v_lshrrev_b32 v2, 6, v0
    s_and_b32 s28, s2, 31
    s_lshr_b32 s29, s2, 5
    v_readfirstlane_b32 s30, v2
    s_nop 3
    s_lshl_b32 s31, s29, 7
    s_lshl_b32 s32, s30, 5
    s_add_u32 s31, s31, s32
    s_waitcnt lgkmcnt(0)
    s_mov_b32 s24, s12
    s_and_b32 s25, s13, 0xffff
    s_mov_b32 s26, 25165824
    s_mov_b32 s27, 0x00020000
    v_and_b32 v2, 31, v1
    v_lshrrev_b32 v3, 5, v1
    v_mul_u32_u24 v4, 40, v2
    v_lshlrev_b32 v5, 4, v3
    v_add_u32 v6, 32, v4
    v_add_u32 v4, v4, v5
    v_lshlrev_b32 v5, 30, v3
    v_add_u32 v6, v6, v5
    s_mul_i32 s34, s28, 81920
    s_mul_i32 s35, s31, 40
    s_add_u32 s35, s35, s34
    buffer_load_dwordx4 v[8:11], v4, s[24:27], s35 offen
    buffer_load_dwordx2 v[12:13], v6, s[24:27], s35 offen
    s_sub_u32 s37, s35, 10240
    s_add_u32 s37, s37, 2621440
    s_cmp_lt_u32 s31, 256
    s_cselect_b32 s46, 0x40000000, 0
    v_lshlrev_b32 v5, 6, v2
    v_lshlrev_b32 v7, 5, v3
    v_add_u32 v5, v5, v7
    v_add_u32 v5, 5242880, v5
    s_lshl_b32 s39, s28, 6
    s_lshr_b32 s38, s31, 5
    s_add_u32 s39, s39, s38
    s_sub_u32 s39, s39, 8
    s_mul_i32 s39, s39, 1280
    s_mul_i32 s34, s28, 40
    v_mov_b32 v14, 0
    v_mov_b32 v15, 0
    v_mov_b32 v22, 0
    v_mov_b32 v23, 0
    v_mov_b32 v30, 0
    v_mov_b32 v31, 0
    v_mov_b32 v38, 0
    v_mov_b32 v39, 0
    s_cmp_lt_u32 s31, 256
    s_cselect_b32 s47, 0x7f000000, s37
    buffer_load_dwordx4 v[16:19], v4, s[24:27], s47 offen
    buffer_load_dwordx2 v[20:21], v6, s[24:27], s47 offen
    s_add_u32 s37, s37, 1280
    s_cmp_lt_u32 s31, 224
    s_cselect_b32 s47, 0x7f000000, s37
    buffer_load_dwordx4 v[24:27], v4, s[24:27], s47 offen
    buffer_load_dwordx2 v[28:29], v6, s[24:27], s47 offen
    s_add_u32 s37, s37, 1280
    s_cmp_lt_u32 s31, 192
    s_cselect_b32 s47, 0x7f000000, s37
    buffer_load_dwordx4 v[32:35], v4, s[24:27], s47 offen
    buffer_load_dwordx2 v[36:37], v6, s[24:27], s47 offen
    s_add_u32 s37, s37, 1280
    s_waitcnt vmcnt(6)
    s_mov_b32 s40, 0x3e64f92e
    s_mov_b32 s41, 0xffff0000
    s_mov_b32 s42, 0xf149f2ca
    s_waitcnt vmcnt(4)
    v_mfma_f32_32x32x16_bf16 v[64:79], v[16:19], v[8:11], 0
    v_mfma_f32_32x32x16_bf16 v[64:79], v[20:23], v[12:15], v[64:79]
    s_cmp_lt_u32 s31, 160
    s_cselect_b32 s47, 0x7f000000, s37
    buffer_load_dwordx4 v[16:19], v4, s[24:27], s47 offen
    buffer_load_dwordx2 v[20:21], v6, s[24:27], s47 offen
    s_add_u32 s37, s37, 1280
    s_waitcnt vmcnt(4)
    v_mfma_f32_32x32x16_bf16 v[80:95], v[24:27], v[8:11], 0
    v_mfma_f32_32x32x16_bf16 v[80:95], v[28:31], v[12:15], v[80:95]
    s_cmp_lt_u32 s31, 128
    s_cselect_b32 s47, 0x7f000000, s37
    buffer_load_dwordx4 v[24:27], v4, s[24:27], s47 offen
    buffer_load_dwordx2 v[28:29], v6, s[24:27], s47 offen
    s_add_u32 s37, s37, 1280
    s_waitcnt vmcnt(4)
    v_mfma_f32_32x32x16_bf16 v[96:111], v[32:35], v[8:11], 0
    v_mfma_f32_32x32x16_bf16 v[96:111], v[36:39], v[12:15], v[96:111]
    s_cmp_lt_u32 s31, 96
    s_cselect_b32 s47, 0x7f000000, s37
    buffer_load_dwordx4 v[32:35], v4, s[24:27], s47 offen
    buffer_load_dwordx2 v[36:37], v6, s[24:27], s47 offen
    s_add_u32 s37, s37, 1280
    s_waitcnt vmcnt(4)
    v_mfma_f32_32x32x16_bf16 v[112:127], v[16:19], v[8:11], 0
    v_mfma_f32_32x32x16_bf16 v[112:127], v[20:23], v[12:15], v[112:127]
    s_cmp_lt_u32 s31, 64
    s_cselect_b32 s47, 0x7f000000, s37
    buffer_load_dwordx4 v[16:19], v4, s[24:27], s47 offen
    buffer_load_dwordx2 v[20:21], v6, s[24:27], s47 offen
    s_add_u32 s37, s37, 1280
    s_waitcnt vmcnt(4)
    v_mfma_f32_32x32x16_bf16 v[128:143], v[24:27], v[8:11], 0
    v_mfma_f32_32x32x16_bf16 v[128:143], v[28:31], v[12:15], v[128:143]
    s_cmp_lt_u32 s31, 32
    s_cselect_b32 s47, 0x7f000000, s37
    buffer_load_dwordx4 v[24:27], v4, s[24:27], s47 offen
    buffer_load_dwordx2 v[28:29], v6, s[24:27], s47 offen
    s_add_u32 s37, s37, 1280
    s_waitcnt vmcnt(4)
    v_mfma_f32_32x32x16_bf16 v[144:159], v[32:35], v[8:11], 0
    v_mfma_f32_32x32x16_bf16 v[144:159], v[36:39], v[12:15], v[144:159]
    s_cmp_lt_u32 s31, 0
    s_cselect_b32 s47, 0x7f000000, s37
    buffer_load_dwordx4 v[32:35], v4, s[24:27], s47 offen
    buffer_load_dwordx2 v[36:37], v6, s[24:27], s47 offen
    s_add_u32 s37, s37, 1280
    s_waitcnt vmcnt(4)
    v_mfma_f32_32x32x16_bf16 v[160:175], v[16:19], v[8:11], 0
    v_mfma_f32_32x32x16_bf16 v[160:175], v[20:23], v[12:15], v[160:175]
    s_waitcnt vmcnt(2)
    v_mfma_f32_32x32x16_bf16 v[176:191], v[24:27], v[8:11], 0
    v_mfma_f32_32x32x16_bf16 v[176:191], v[28:31], v[12:15], v[176:191]
    s_waitcnt vmcnt(0)
    v_mfma_f32_32x32x16_bf16 v[192:207], v[32:35], v[8:11], 0
    v_mfma_f32_32x32x16_bf16 v[192:207], v[36:39], v[12:15], v[192:207]
    s_cmp_lt_u32 s31, 256
    s_cselect_b32 s47, 0x7f000000, s39
    buffer_load_dwordx4 v[208:211], v5, s[24:27], s47 offen
    buffer_load_dwordx4 v[212:215], v5, s[24:27], s47 offen offset:16
    s_add_u32 s39, s39, 1280
    s_cmp_lt_u32 s31, 224
    s_cselect_b32 s47, 0x7f000000, s39
    buffer_load_dwordx4 v[216:219], v5, s[24:27], s47 offen
    buffer_load_dwordx4 v[220:223], v5, s[24:27], s47 offen offset:16
    s_add_u32 s39, s39, 1280
    s_cmp_lt_u32 s31, 192
    s_cselect_b32 s47, 0x7f000000, s39
    buffer_load_dwordx4 v[224:227], v5, s[24:27], s47 offen
    buffer_load_dwordx4 v[228:231], v5, s[24:27], s47 offen offset:16
    s_add_u32 s39, s39, 1280
    s_nop 7
    s_nop 7
    v_cvt_pk_bf16_f32 v56, v64, v65
    v_lshlrev_b32 v64, 16, v56
    v_and_b32 v65, s41, v56
    v_mul_f32 v64, s40, v64
    v_mul_f32 v65, s40, v65
    v_cvt_pk_bf16_f32 v56, v64, v65
    v_lshlrev_b32 v64, 16, v56
    v_and_b32 v65, s41, v56
    v_cvt_pk_bf16_f32 v56, v66, v67
    v_lshlrev_b32 v66, 16, v56
    v_and_b32 v67, s41, v56
    v_mul_f32 v66, s40, v66
    v_mul_f32 v67, s40, v67
    v_cvt_pk_bf16_f32 v56, v66, v67
    v_lshlrev_b32 v66, 16, v56
    v_and_b32 v67, s41, v56
    v_cvt_pk_bf16_f32 v56, v68, v69
    v_lshlrev_b32 v68, 16, v56
    v_and_b32 v69, s41, v56
    v_mul_f32 v68, s40, v68
    v_mul_f32 v69, s40, v69
    v_cvt_pk_bf16_f32 v56, v68, v69
    v_lshlrev_b32 v68, 16, v56
    v_and_b32 v69, s41, v56
    v_cvt_pk_bf16_f32 v56, v70, v71
    v_lshlrev_b32 v70, 16, v56
    v_and_b32 v71, s41, v56
    v_mul_f32 v70, s40, v70
    v_mul_f32 v71, s40, v71
    v_cvt_pk_bf16_f32 v56, v70, v71
    v_lshlrev_b32 v70, 16, v56
    v_and_b32 v71, s41, v56
    v_cvt_pk_bf16_f32 v56, v72, v73
    v_lshlrev_b32 v72, 16, v56
    v_and_b32 v73, s41, v56
    v_mul_f32 v72, s40, v72
    v_mul_f32 v73, s40, v73
    v_cvt_pk_bf16_f32 v56, v72, v73
    v_lshlrev_b32 v72, 16, v56
    v_and_b32 v73, s41, v56
    v_cvt_pk_bf16_f32 v56, v74, v75
    v_lshlrev_b32 v74, 16, v56
    v_and_b32 v75, s41, v56
    v_mul_f32 v74, s40, v74
    v_mul_f32 v75, s40, v75
    v_cvt_pk_bf16_f32 v56, v74, v75
    v_lshlrev_b32 v74, 16, v56
    v_and_b32 v75, s41, v56
    v_cvt_pk_bf16_f32 v56, v76, v77
    v_lshlrev_b32 v76, 16, v56
    v_and_b32 v77, s41, v56
    v_mul_f32 v76, s40, v76
    v_mul_f32 v77, s40, v77
    v_cvt_pk_bf16_f32 v56, v76, v77
    v_lshlrev_b32 v76, 16, v56
    v_and_b32 v77, s41, v56
    v_cvt_pk_bf16_f32 v56, v78, v79
    v_lshlrev_b32 v78, 16, v56
    v_and_b32 v79, s41, v56
    v_mul_f32 v78, s40, v78
    v_mul_f32 v79, s40, v79
    v_cvt_pk_bf16_f32 v56, v78, v79
    v_lshlrev_b32 v78, 16, v56
    v_and_b32 v79, s41, v56
    v_cvt_pk_bf16_f32 v56, v80, v81
    v_lshlrev_b32 v80, 16, v56
    v_and_b32 v81, s41, v56
    v_mul_f32 v80, s40, v80
    v_mul_f32 v81, s40, v81
    v_cvt_pk_bf16_f32 v56, v80, v81
    v_lshlrev_b32 v80, 16, v56
    v_and_b32 v81, s41, v56
    v_cvt_pk_bf16_f32 v56, v82, v83
    v_lshlrev_b32 v82, 16, v56
    v_and_b32 v83, s41, v56
    v_mul_f32 v82, s40, v82
    v_mul_f32 v83, s40, v83
    v_cvt_pk_bf16_f32 v56, v82, v83
    v_lshlrev_b32 v82, 16, v56
    v_and_b32 v83, s41, v56
    v_cvt_pk_bf16_f32 v56, v84, v85
    v_lshlrev_b32 v84, 16, v56
    v_and_b32 v85, s41, v56
    v_mul_f32 v84, s40, v84
    v_mul_f32 v85, s40, v85
    v_cvt_pk_bf16_f32 v56, v84, v85
    v_lshlrev_b32 v84, 16, v56
    v_and_b32 v85, s41, v56
    v_cvt_pk_bf16_f32 v56, v86, v87
    v_lshlrev_b32 v86, 16, v56
    v_and_b32 v87, s41, v56
    v_mul_f32 v86, s40, v86
    v_mul_f32 v87, s40, v87
    v_cvt_pk_bf16_f32 v56, v86, v87
    v_lshlrev_b32 v86, 16, v56
    v_and_b32 v87, s41, v56
    v_cvt_pk_bf16_f32 v56, v88, v89
    v_lshlrev_b32 v88, 16, v56
    v_and_b32 v89, s41, v56
    v_mul_f32 v88, s40, v88
    v_mul_f32 v89, s40, v89
    v_cvt_pk_bf16_f32 v56, v88, v89
    v_lshlrev_b32 v88, 16, v56
    v_and_b32 v89, s41, v56
    v_cvt_pk_bf16_f32 v56, v90, v91
    v_lshlrev_b32 v90, 16, v56
    v_and_b32 v91, s41, v56
    v_mul_f32 v90, s40, v90
    v_mul_f32 v91, s40, v91
    v_cvt_pk_bf16_f32 v56, v90, v91
    v_lshlrev_b32 v90, 16, v56
    v_and_b32 v91, s41, v56
    v_cvt_pk_bf16_f32 v56, v92, v93
    v_lshlrev_b32 v92, 16, v56
    v_and_b32 v93, s41, v56
    v_mul_f32 v92, s40, v92
    v_mul_f32 v93, s40, v93
    v_cvt_pk_bf16_f32 v56, v92, v93
    v_lshlrev_b32 v92, 16, v56
    v_and_b32 v93, s41, v56
    v_cvt_pk_bf16_f32 v56, v94, v95
    v_lshlrev_b32 v94, 16, v56
    v_and_b32 v95, s41, v56
    v_mul_f32 v94, s40, v94
    v_mul_f32 v95, s40, v95
    v_cvt_pk_bf16_f32 v56, v94, v95
    v_lshlrev_b32 v94, 16, v56
    v_and_b32 v95, s41, v56
    v_cvt_pk_bf16_f32 v56, v96, v97
    v_lshlrev_b32 v96, 16, v56
    v_and_b32 v97, s41, v56
    v_mul_f32 v96, s40, v96
    v_mul_f32 v97, s40, v97
    v_cvt_pk_bf16_f32 v56, v96, v97
    v_lshlrev_b32 v96, 16, v56
    v_and_b32 v97, s41, v56
    v_cvt_pk_bf16_f32 v56, v98, v99
    v_lshlrev_b32 v98, 16, v56
    v_and_b32 v99, s41, v56
    v_mul_f32 v98, s40, v98
    v_mul_f32 v99, s40, v99
    v_cvt_pk_bf16_f32 v56, v98, v99
    v_lshlrev_b32 v98, 16, v56
    v_and_b32 v99, s41, v56
    v_cvt_pk_bf16_f32 v56, v100, v101
    v_lshlrev_b32 v100, 16, v56
    v_and_b32 v101, s41, v56
    v_mul_f32 v100, s40, v100
    v_mul_f32 v101, s40, v101
    v_cvt_pk_bf16_f32 v56, v100, v101
    v_lshlrev_b32 v100, 16, v56
    v_and_b32 v101, s41, v56
    v_cvt_pk_bf16_f32 v56, v102, v103
    v_lshlrev_b32 v102, 16, v56
    v_and_b32 v103, s41, v56
    v_mul_f32 v102, s40, v102
    v_mul_f32 v103, s40, v103
    v_cvt_pk_bf16_f32 v56, v102, v103
    v_lshlrev_b32 v102, 16, v56
    v_and_b32 v103, s41, v56
    v_cvt_pk_bf16_f32 v56, v104, v105
    v_lshlrev_b32 v104, 16, v56
    v_and_b32 v105, s41, v56
    v_mul_f32 v104, s40, v104
    v_mul_f32 v105, s40, v105
    v_cvt_pk_bf16_f32 v56, v104, v105
    v_lshlrev_b32 v104, 16, v56
    v_and_b32 v105, s41, v56
    v_cvt_pk_bf16_f32 v56, v106, v107
    v_lshlrev_b32 v106, 16, v56
    v_and_b32 v107, s41, v56
    v_mul_f32 v106, s40, v106
    v_mul_f32 v107, s40, v107
    v_cvt_pk_bf16_f32 v56, v106, v107
    v_lshlrev_b32 v106, 16, v56
    v_and_b32 v107, s41, v56
    v_cvt_pk_bf16_f32 v56, v108, v109
    v_lshlrev_b32 v108, 16, v56
    v_and_b32 v109, s41, v56
    v_mul_f32 v108, s40, v108
    v_mul_f32 v109, s40, v109
    v_cvt_pk_bf16_f32 v56, v108, v109
    v_lshlrev_b32 v108, 16, v56
    v_and_b32 v109, s41, v56
    v_cvt_pk_bf16_f32 v56, v110, v111
    v_lshlrev_b32 v110, 16, v56
    v_and_b32 v111, s41, v56
    v_mul_f32 v110, s40, v110
    v_mul_f32 v111, s40, v111
    v_cvt_pk_bf16_f32 v56, v110, v111
    v_lshlrev_b32 v110, 16, v56
    v_and_b32 v111, s41, v56
    v_cvt_pk_bf16_f32 v56, v112, v113
    v_lshlrev_b32 v112, 16, v56
    v_and_b32 v113, s41, v56
    v_mul_f32 v112, s40, v112
    v_mul_f32 v113, s40, v113
    v_cvt_pk_bf16_f32 v56, v112, v113
    v_lshlrev_b32 v112, 16, v56
    v_and_b32 v113, s41, v56
    v_cvt_pk_bf16_f32 v56, v114, v115
    v_lshlrev_b32 v114, 16, v56
    v_and_b32 v115, s41, v56
    v_mul_f32 v114, s40, v114
    v_mul_f32 v115, s40, v115
    v_cvt_pk_bf16_f32 v56, v114, v115
    v_lshlrev_b32 v114, 16, v56
    v_and_b32 v115, s41, v56
    v_cvt_pk_bf16_f32 v56, v116, v117
    v_lshlrev_b32 v116, 16, v56
    v_and_b32 v117, s41, v56
    v_mul_f32 v116, s40, v116
    v_mul_f32 v117, s40, v117
    v_cvt_pk_bf16_f32 v56, v116, v117
    v_lshlrev_b32 v116, 16, v56
    v_and_b32 v117, s41, v56
    v_cvt_pk_bf16_f32 v56, v118, v119
    v_lshlrev_b32 v118, 16, v56
    v_and_b32 v119, s41, v56
    v_mul_f32 v118, s40, v118
    v_mul_f32 v119, s40, v119
    v_cvt_pk_bf16_f32 v56, v118, v119
    v_lshlrev_b32 v118, 16, v56
    v_and_b32 v119, s41, v56
    v_cvt_pk_bf16_f32 v56, v120, v121
    v_lshlrev_b32 v120, 16, v56
    v_and_b32 v121, s41, v56
    v_mul_f32 v120, s40, v120
    v_mul_f32 v121, s40, v121
    v_cvt_pk_bf16_f32 v56, v120, v121
    v_lshlrev_b32 v120, 16, v56
    v_and_b32 v121, s41, v56
    v_cvt_pk_bf16_f32 v56, v122, v123
    v_lshlrev_b32 v122, 16, v56
    v_and_b32 v123, s41, v56
    v_mul_f32 v122, s40, v122
    v_mul_f32 v123, s40, v123
    v_cvt_pk_bf16_f32 v56, v122, v123
    v_lshlrev_b32 v122, 16, v56
    v_and_b32 v123, s41, v56
    v_cvt_pk_bf16_f32 v56, v124, v125
    v_lshlrev_b32 v124, 16, v56
    v_and_b32 v125, s41, v56
    v_mul_f32 v124, s40, v124
    v_mul_f32 v125, s40, v125
    v_cvt_pk_bf16_f32 v56, v124, v125
    v_lshlrev_b32 v124, 16, v56
    v_and_b32 v125, s41, v56
    v_cvt_pk_bf16_f32 v56, v126, v127
    v_lshlrev_b32 v126, 16, v56
    v_and_b32 v127, s41, v56
    v_mul_f32 v126, s40, v126
    v_mul_f32 v127, s40, v127
    v_cvt_pk_bf16_f32 v56, v126, v127
    v_lshlrev_b32 v126, 16, v56
    v_and_b32 v127, s41, v56
    v_cvt_pk_bf16_f32 v56, v128, v129
    v_lshlrev_b32 v128, 16, v56
    v_and_b32 v129, s41, v56
    v_mul_f32 v128, s40, v128
    v_mul_f32 v129, s40, v129
    v_cvt_pk_bf16_f32 v56, v128, v129
    v_lshlrev_b32 v128, 16, v56
    v_and_b32 v129, s41, v56
    v_cvt_pk_bf16_f32 v56, v130, v131
    v_lshlrev_b32 v130, 16, v56
    v_and_b32 v131, s41, v56
    v_mul_f32 v130, s40, v130
    v_mul_f32 v131, s40, v131
    v_cvt_pk_bf16_f32 v56, v130, v131
    v_lshlrev_b32 v130, 16, v56
    v_and_b32 v131, s41, v56
    v_cvt_pk_bf16_f32 v56, v132, v133
    v_lshlrev_b32 v132, 16, v56
    v_and_b32 v133, s41, v56
    v_mul_f32 v132, s40, v132
    v_mul_f32 v133, s40, v133
    v_cvt_pk_bf16_f32 v56, v132, v133
    v_lshlrev_b32 v132, 16, v56
    v_and_b32 v133, s41, v56
    v_cvt_pk_bf16_f32 v56, v134, v135
    v_lshlrev_b32 v134, 16, v56
    v_and_b32 v135, s41, v56
    v_mul_f32 v134, s40, v134
    v_mul_f32 v135, s40, v135
    v_cvt_pk_bf16_f32 v56, v134, v135
    v_lshlrev_b32 v134, 16, v56
    v_and_b32 v135, s41, v56
    v_cvt_pk_bf16_f32 v56, v136, v137
    v_lshlrev_b32 v136, 16, v56
    v_and_b32 v137, s41, v56
    v_mul_f32 v136, s40, v136
    v_mul_f32 v137, s40, v137
    v_cvt_pk_bf16_f32 v56, v136, v137
    v_lshlrev_b32 v136, 16, v56
    v_and_b32 v137, s41, v56
    v_cvt_pk_bf16_f32 v56, v138, v139
    v_lshlrev_b32 v138, 16, v56
    v_and_b32 v139, s41, v56
    v_mul_f32 v138, s40, v138
    v_mul_f32 v139, s40, v139
    v_cvt_pk_bf16_f32 v56, v138, v139
    v_lshlrev_b32 v138, 16, v56
    v_and_b32 v139, s41, v56
    v_cvt_pk_bf16_f32 v56, v140, v141
    v_lshlrev_b32 v140, 16, v56
    v_and_b32 v141, s41, v56
    v_mul_f32 v140, s40, v140
    v_mul_f32 v141, s40, v141
    v_cvt_pk_bf16_f32 v56, v140, v141
    v_lshlrev_b32 v140, 16, v56
    v_and_b32 v141, s41, v56
    v_cvt_pk_bf16_f32 v56, v142, v143
    v_lshlrev_b32 v142, 16, v56
    v_and_b32 v143, s41, v56
    v_mul_f32 v142, s40, v142
    v_mul_f32 v143, s40, v143
    v_cvt_pk_bf16_f32 v56, v142, v143
    v_lshlrev_b32 v142, 16, v56
    v_and_b32 v143, s41, v56
    v_cvt_pk_bf16_f32 v56, v144, v145
    v_lshlrev_b32 v144, 16, v56
    v_and_b32 v145, s41, v56
    v_mul_f32 v144, s40, v144
    v_mul_f32 v145, s40, v145
    v_cvt_pk_bf16_f32 v56, v144, v145
    v_lshlrev_b32 v144, 16, v56
    v_and_b32 v145, s41, v56
    v_cvt_pk_bf16_f32 v56, v146, v147
    v_lshlrev_b32 v146, 16, v56
    v_and_b32 v147, s41, v56
    v_mul_f32 v146, s40, v146
    v_mul_f32 v147, s40, v147
    v_cvt_pk_bf16_f32 v56, v146, v147
    v_lshlrev_b32 v146, 16, v56
    v_and_b32 v147, s41, v56
    v_cvt_pk_bf16_f32 v56, v148, v149
    v_lshlrev_b32 v148, 16, v56
    v_and_b32 v149, s41, v56
    v_mul_f32 v148, s40, v148
    v_mul_f32 v149, s40, v149
    v_cvt_pk_bf16_f32 v56, v148, v149
    v_lshlrev_b32 v148, 16, v56
    v_and_b32 v149, s41, v56
    v_cvt_pk_bf16_f32 v56, v150, v151
    v_lshlrev_b32 v150, 16, v56
    v_and_b32 v151, s41, v56
    v_mul_f32 v150, s40, v150
    v_mul_f32 v151, s40, v151
    v_cvt_pk_bf16_f32 v56, v150, v151
    v_lshlrev_b32 v150, 16, v56
    v_and_b32 v151, s41, v56
    v_cvt_pk_bf16_f32 v56, v152, v153
    v_lshlrev_b32 v152, 16, v56
    v_and_b32 v153, s41, v56
    v_mul_f32 v152, s40, v152
    v_mul_f32 v153, s40, v153
    v_cvt_pk_bf16_f32 v56, v152, v153
    v_lshlrev_b32 v152, 16, v56
    v_and_b32 v153, s41, v56
    v_cvt_pk_bf16_f32 v56, v154, v155
    v_lshlrev_b32 v154, 16, v56
    v_and_b32 v155, s41, v56
    v_mul_f32 v154, s40, v154
    v_mul_f32 v155, s40, v155
    v_cvt_pk_bf16_f32 v56, v154, v155
    v_lshlrev_b32 v154, 16, v56
    v_and_b32 v155, s41, v56
    v_cvt_pk_bf16_f32 v56, v156, v157
    v_lshlrev_b32 v156, 16, v56
    v_and_b32 v157, s41, v56
    v_mul_f32 v156, s40, v156
    v_mul_f32 v157, s40, v157
    v_cvt_pk_bf16_f32 v56, v156, v157
    v_lshlrev_b32 v156, 16, v56
    v_and_b32 v157, s41, v56
    v_cvt_pk_bf16_f32 v56, v158, v159
    v_lshlrev_b32 v158, 16, v56
    v_and_b32 v159, s41, v56
    v_mul_f32 v158, s40, v158
    v_mul_f32 v159, s40, v159
    v_cvt_pk_bf16_f32 v56, v158, v159
    v_lshlrev_b32 v158, 16, v56
    v_and_b32 v159, s41, v56
    v_cvt_pk_bf16_f32 v56, v160, v161
    v_lshlrev_b32 v160, 16, v56
    v_and_b32 v161, s41, v56
    v_mul_f32 v160, s40, v160
    v_mul_f32 v161, s40, v161
    v_cvt_pk_bf16_f32 v56, v160, v161
    v_lshlrev_b32 v160, 16, v56
    v_and_b32 v161, s41, v56
    v_cvt_pk_bf16_f32 v56, v162, v163
    v_lshlrev_b32 v162, 16, v56
    v_and_b32 v163, s41, v56
    v_mul_f32 v162, s40, v162
    v_mul_f32 v163, s40, v163
    v_cvt_pk_bf16_f32 v56, v162, v163
    v_lshlrev_b32 v162, 16, v56
    v_and_b32 v163, s41, v56
    v_cvt_pk_bf16_f32 v56, v164, v165
    v_lshlrev_b32 v164, 16, v56
    v_and_b32 v165, s41, v56
    v_mul_f32 v164, s40, v164
    v_mul_f32 v165, s40, v165
    v_cvt_pk_bf16_f32 v56, v164, v165
    v_lshlrev_b32 v164, 16, v56
    v_and_b32 v165, s41, v56
    v_cvt_pk_bf16_f32 v56, v166, v167
    v_lshlrev_b32 v166, 16, v56
    v_and_b32 v167, s41, v56
    v_mul_f32 v166, s40, v166
    v_mul_f32 v167, s40, v167
    v_cvt_pk_bf16_f32 v56, v166, v167
    v_lshlrev_b32 v166, 16, v56
    v_and_b32 v167, s41, v56
    v_cvt_pk_bf16_f32 v56, v168, v169
    v_lshlrev_b32 v168, 16, v56
    v_and_b32 v169, s41, v56
    v_mul_f32 v168, s40, v168
    v_mul_f32 v169, s40, v169
    v_cvt_pk_bf16_f32 v56, v168, v169
    v_lshlrev_b32 v168, 16, v56
    v_and_b32 v169, s41, v56
    v_cvt_pk_bf16_f32 v56, v170, v171
    v_lshlrev_b32 v170, 16, v56
    v_and_b32 v171, s41, v56
    v_mul_f32 v170, s40, v170
    v_mul_f32 v171, s40, v171
    v_cvt_pk_bf16_f32 v56, v170, v171
    v_lshlrev_b32 v170, 16, v56
    v_and_b32 v171, s41, v56
    v_cvt_pk_bf16_f32 v56, v172, v173
    v_lshlrev_b32 v172, 16, v56
    v_and_b32 v173, s41, v56
    v_mul_f32 v172, s40, v172
    v_mul_f32 v173, s40, v173
    v_cvt_pk_bf16_f32 v56, v172, v173
    v_lshlrev_b32 v172, 16, v56
    v_and_b32 v173, s41, v56
    v_cvt_pk_bf16_f32 v56, v174, v175
    v_lshlrev_b32 v174, 16, v56
    v_and_b32 v175, s41, v56
    v_mul_f32 v174, s40, v174
    v_mul_f32 v175, s40, v175
    v_cvt_pk_bf16_f32 v56, v174, v175
    v_lshlrev_b32 v174, 16, v56
    v_and_b32 v175, s41, v56
    v_cvt_pk_bf16_f32 v56, v176, v177
    v_lshlrev_b32 v176, 16, v56
    v_and_b32 v177, s41, v56
    v_mul_f32 v176, s40, v176
    v_mul_f32 v177, s40, v177
    v_cvt_pk_bf16_f32 v56, v176, v177
    v_lshlrev_b32 v176, 16, v56
    v_and_b32 v177, s41, v56
    v_cvt_pk_bf16_f32 v56, v178, v179
    v_lshlrev_b32 v178, 16, v56
    v_and_b32 v179, s41, v56
    v_mul_f32 v178, s40, v178
    v_mul_f32 v179, s40, v179
    v_cvt_pk_bf16_f32 v56, v178, v179
    v_lshlrev_b32 v178, 16, v56
    v_and_b32 v179, s41, v56
    v_cvt_pk_bf16_f32 v56, v180, v181
    v_lshlrev_b32 v180, 16, v56
    v_and_b32 v181, s41, v56
    v_mul_f32 v180, s40, v180
    v_mul_f32 v181, s40, v181
    v_cvt_pk_bf16_f32 v56, v180, v181
    v_lshlrev_b32 v180, 16, v56
    v_and_b32 v181, s41, v56
    v_cvt_pk_bf16_f32 v56, v182, v183
    v_lshlrev_b32 v182, 16, v56
    v_and_b32 v183, s41, v56
    v_mul_f32 v182, s40, v182
    v_mul_f32 v183, s40, v183
    v_cvt_pk_bf16_f32 v56, v182, v183
    v_lshlrev_b32 v182, 16, v56
    v_and_b32 v183, s41, v56
    v_cvt_pk_bf16_f32 v56, v184, v185
    v_lshlrev_b32 v184, 16, v56
    v_and_b32 v185, s41, v56
    v_mul_f32 v184, s40, v184
    v_mul_f32 v185, s40, v185
    v_cvt_pk_bf16_f32 v56, v184, v185
    v_lshlrev_b32 v184, 16, v56
    v_and_b32 v185, s41, v56
    v_cvt_pk_bf16_f32 v56, v186, v187
    v_lshlrev_b32 v186, 16, v56
    v_and_b32 v187, s41, v56
    v_mul_f32 v186, s40, v186
    v_mul_f32 v187, s40, v187
    v_cvt_pk_bf16_f32 v56, v186, v187
    v_lshlrev_b32 v186, 16, v56
    v_and_b32 v187, s41, v56
    v_cvt_pk_bf16_f32 v56, v188, v189
    v_lshlrev_b32 v188, 16, v56
    v_and_b32 v189, s41, v56
    v_mul_f32 v188, s40, v188
    v_mul_f32 v189, s40, v189
    v_cvt_pk_bf16_f32 v56, v188, v189
    v_lshlrev_b32 v188, 16, v56
    v_and_b32 v189, s41, v56
    v_cvt_pk_bf16_f32 v56, v190, v191
    v_lshlrev_b32 v190, 16, v56
    v_and_b32 v191, s41, v56
    v_mul_f32 v190, s40, v190
    v_mul_f32 v191, s40, v191
    v_cvt_pk_bf16_f32 v56, v190, v191
    v_lshlrev_b32 v190, 16, v56
    v_and_b32 v191, s41, v56
    v_cvt_pk_bf16_f32 v56, v192, v193
    v_lshlrev_b32 v192, 16, v56
    v_and_b32 v193, s41, v56
    v_mul_f32 v192, s40, v192
    v_mul_f32 v193, s40, v193
    v_cvt_pk_bf16_f32 v56, v192, v193
    v_lshlrev_b32 v192, 16, v56
    v_and_b32 v193, s41, v56
    v_cvt_pk_bf16_f32 v56, v194, v195
    v_lshlrev_b32 v194, 16, v56
    v_and_b32 v195, s41, v56
    v_mul_f32 v194, s40, v194
    v_mul_f32 v195, s40, v195
    v_cvt_pk_bf16_f32 v56, v194, v195
    v_lshlrev_b32 v194, 16, v56
    v_and_b32 v195, s41, v56
    v_cvt_pk_bf16_f32 v56, v196, v197
    v_lshlrev_b32 v196, 16, v56
    v_and_b32 v197, s41, v56
    v_mul_f32 v196, s40, v196
    v_mul_f32 v197, s40, v197
    v_cvt_pk_bf16_f32 v56, v196, v197
    v_lshlrev_b32 v196, 16, v56
    v_and_b32 v197, s41, v56
    v_cvt_pk_bf16_f32 v56, v198, v199
    v_lshlrev_b32 v198, 16, v56
    v_and_b32 v199, s41, v56
    v_mul_f32 v198, s40, v198
    v_mul_f32 v199, s40, v199
    v_cvt_pk_bf16_f32 v56, v198, v199
    v_lshlrev_b32 v198, 16, v56
    v_and_b32 v199, s41, v56
    v_cvt_pk_bf16_f32 v56, v200, v201
    v_lshlrev_b32 v200, 16, v56
    v_and_b32 v201, s41, v56
    v_mul_f32 v200, s40, v200
    v_mul_f32 v201, s40, v201
    v_cvt_pk_bf16_f32 v56, v200, v201
    v_lshlrev_b32 v200, 16, v56
    v_and_b32 v201, s41, v56
    v_cvt_pk_bf16_f32 v56, v202, v203
    v_lshlrev_b32 v202, 16, v56
    v_and_b32 v203, s41, v56
    v_mul_f32 v202, s40, v202
    v_mul_f32 v203, s40, v203
    v_cvt_pk_bf16_f32 v56, v202, v203
    v_lshlrev_b32 v202, 16, v56
    v_and_b32 v203, s41, v56
    v_cvt_pk_bf16_f32 v56, v204, v205
    v_lshlrev_b32 v204, 16, v56
    v_and_b32 v205, s41, v56
    v_mul_f32 v204, s40, v204
    v_mul_f32 v205, s40, v205
    v_cvt_pk_bf16_f32 v56, v204, v205
    v_lshlrev_b32 v204, 16, v56
    v_and_b32 v205, s41, v56
    v_cvt_pk_bf16_f32 v56, v206, v207
    v_lshlrev_b32 v206, 16, v56
    v_and_b32 v207, s41, v56
    v_mul_f32 v206, s40, v206
    v_mul_f32 v207, s40, v207
    v_cvt_pk_bf16_f32 v56, v206, v207
    v_lshlrev_b32 v206, 16, v56
    v_and_b32 v207, s41, v56
    v_lshlrev_b32 v56, 2, v3
    v_sub_u32 v56, v2, v56
    v_mov_b32 v57, s42
    v_cmp_le_i32 vcc, 0, v56
    s_nop 1
    v_cndmask_b32 v64, v64, v57, vcc
    v_cndmask_b32 v192, v57, v192, vcc
    v_cmp_le_i32 vcc, 1, v56
    s_nop 1
    v_cndmask_b32 v65, v65, v57, vcc
    v_cndmask_b32 v193, v57, v193, vcc
    v_cmp_le_i32 vcc, 2, v56
    s_nop 1
    v_cndmask_b32 v66, v66, v57, vcc
    v_cndmask_b32 v194, v57, v194, vcc
    v_cmp_le_i32 vcc, 3, v56
    s_nop 1
    v_cndmask_b32 v67, v67, v57, vcc
    v_cndmask_b32 v195, v57, v195, vcc
    v_cmp_le_i32 vcc, 8, v56
    s_nop 1
    v_cndmask_b32 v68, v68, v57, vcc
    v_cndmask_b32 v196, v57, v196, vcc
    v_cmp_le_i32 vcc, 9, v56
    s_nop 1
    v_cndmask_b32 v69, v69, v57, vcc
    v_cndmask_b32 v197, v57, v197, vcc
    v_cmp_le_i32 vcc, 10, v56
    s_nop 1
    v_cndmask_b32 v70, v70, v57, vcc
    v_cndmask_b32 v198, v57, v198, vcc
    v_cmp_le_i32 vcc, 11, v56
    s_nop 1
    v_cndmask_b32 v71, v71, v57, vcc
    v_cndmask_b32 v199, v57, v199, vcc
    v_cmp_le_i32 vcc, 16, v56
    s_nop 1
    v_cndmask_b32 v72, v72, v57, vcc
    v_cndmask_b32 v200, v57, v200, vcc
    v_cmp_le_i32 vcc, 17, v56
    s_nop 1
    v_cndmask_b32 v73, v73, v57, vcc
    v_cndmask_b32 v201, v57, v201, vcc
    v_cmp_le_i32 vcc, 18, v56
    s_nop 1
    v_cndmask_b32 v74, v74, v57, vcc
    v_cndmask_b32 v202, v57, v202, vcc
    v_cmp_le_i32 vcc, 19, v56
    s_nop 1
    v_cndmask_b32 v75, v75, v57, vcc
    v_cndmask_b32 v203, v57, v203, vcc
    v_cmp_le_i32 vcc, 24, v56
    s_nop 1
    v_cndmask_b32 v76, v76, v57, vcc
    v_cndmask_b32 v204, v57, v204, vcc
    v_cmp_le_i32 vcc, 25, v56
    s_nop 1
    v_cndmask_b32 v77, v77, v57, vcc
    v_cndmask_b32 v205, v57, v205, vcc
    v_cmp_le_i32 vcc, 26, v56
    s_nop 1
    v_cndmask_b32 v78, v78, v57, vcc
    v_cndmask_b32 v206, v57, v206, vcc
    v_cmp_le_i32 vcc, 27, v56
    s_nop 1
    v_cndmask_b32 v79, v79, v57, vcc
    v_cndmask_b32 v207, v57, v207, vcc
    s_cmp_ge_u32 s31, 256
    s_cbranch_scc1 k2_kernel_tv0
    v_mov_b32 v64, s42
    v_mov_b32 v65, s42
    v_mov_b32 v66, s42
    v_mov_b32 v67, s42
    v_mov_b32 v68, s42
    v_mov_b32 v69, s42
    v_mov_b32 v70, s42
    v_mov_b32 v71, s42
    v_mov_b32 v72, s42
    v_mov_b32 v73, s42
    v_mov_b32 v74, s42
    v_mov_b32 v75, s42
    v_mov_b32 v76, s42
    v_mov_b32 v77, s42
    v_mov_b32 v78, s42
    v_mov_b32 v79, s42
k2_kernel_tv0:
    s_cmp_ge_u32 s31, 224
    s_cbranch_scc1 k2_kernel_tv1
    v_mov_b32 v80, s42
    v_mov_b32 v81, s42
    v_mov_b32 v82, s42
    v_mov_b32 v83, s42
    v_mov_b32 v84, s42
    v_mov_b32 v85, s42
    v_mov_b32 v86, s42
    v_mov_b32 v87, s42
    v_mov_b32 v88, s42
    v_mov_b32 v89, s42
    v_mov_b32 v90, s42
    v_mov_b32 v91, s42
    v_mov_b32 v92, s42
    v_mov_b32 v93, s42
    v_mov_b32 v94, s42
    v_mov_b32 v95, s42
k2_kernel_tv1:
    s_cmp_ge_u32 s31, 192
    s_cbranch_scc1 k2_kernel_tv2
    v_mov_b32 v96, s42
    v_mov_b32 v97, s42
    v_mov_b32 v98, s42
    v_mov_b32 v99, s42
    v_mov_b32 v100, s42
    v_mov_b32 v101, s42
    v_mov_b32 v102, s42
    v_mov_b32 v103, s42
    v_mov_b32 v104, s42
    v_mov_b32 v105, s42
    v_mov_b32 v106, s42
    v_mov_b32 v107, s42
    v_mov_b32 v108, s42
    v_mov_b32 v109, s42
    v_mov_b32 v110, s42
    v_mov_b32 v111, s42
k2_kernel_tv2:
    s_cmp_ge_u32 s31, 160
    s_cbranch_scc1 k2_kernel_tv3
    v_mov_b32 v112, s42
    v_mov_b32 v113, s42
    v_mov_b32 v114, s42
    v_mov_b32 v115, s42
    v_mov_b32 v116, s42
    v_mov_b32 v117, s42
    v_mov_b32 v118, s42
    v_mov_b32 v119, s42
    v_mov_b32 v120, s42
    v_mov_b32 v121, s42
    v_mov_b32 v122, s42
    v_mov_b32 v123, s42
    v_mov_b32 v124, s42
    v_mov_b32 v125, s42
    v_mov_b32 v126, s42
    v_mov_b32 v127, s42
k2_kernel_tv3:
    s_cmp_ge_u32 s31, 128
    s_cbranch_scc1 k2_kernel_tv4
    v_mov_b32 v128, s42
    v_mov_b32 v129, s42
    v_mov_b32 v130, s42
    v_mov_b32 v131, s42
    v_mov_b32 v132, s42
    v_mov_b32 v133, s42
    v_mov_b32 v134, s42
    v_mov_b32 v135, s42
    v_mov_b32 v136, s42
    v_mov_b32 v137, s42
    v_mov_b32 v138, s42
    v_mov_b32 v139, s42
    v_mov_b32 v140, s42
    v_mov_b32 v141, s42
    v_mov_b32 v142, s42
    v_mov_b32 v143, s42
k2_kernel_tv4:
    s_cmp_ge_u32 s31, 96
    s_cbranch_scc1 k2_kernel_tv5
    v_mov_b32 v144, s42
    v_mov_b32 v145, s42
    v_mov_b32 v146, s42
    v_mov_b32 v147, s42
    v_mov_b32 v148, s42
    v_mov_b32 v149, s42
    v_mov_b32 v150, s42
    v_mov_b32 v151, s42
    v_mov_b32 v152, s42
    v_mov_b32 v153, s42
    v_mov_b32 v154, s42
    v_mov_b32 v155, s42
    v_mov_b32 v156, s42
    v_mov_b32 v157, s42
    v_mov_b32 v158, s42
    v_mov_b32 v159, s42
k2_kernel_tv5:
    s_cmp_ge_u32 s31, 64
    s_cbranch_scc1 k2_kernel_tv6
    v_mov_b32 v160, s42
    v_mov_b32 v161, s42
    v_mov_b32 v162, s42
    v_mov_b32 v163, s42
    v_mov_b32 v164, s42
    v_mov_b32 v165, s42
    v_mov_b32 v166, s42
    v_mov_b32 v167, s42
    v_mov_b32 v168, s42
    v_mov_b32 v169, s42
    v_mov_b32 v170, s42
    v_mov_b32 v171, s42
    v_mov_b32 v172, s42
    v_mov_b32 v173, s42
    v_mov_b32 v174, s42
    v_mov_b32 v175, s42
k2_kernel_tv6:
    s_cmp_ge_u32 s31, 32
    s_cbranch_scc1 k2_kernel_tv7
    v_mov_b32 v176, s42
    v_mov_b32 v177, s42
    v_mov_b32 v178, s42
    v_mov_b32 v179, s42
    v_mov_b32 v180, s42
    v_mov_b32 v181, s42
    v_mov_b32 v182, s42
    v_mov_b32 v183, s42
    v_mov_b32 v184, s42
    v_mov_b32 v185, s42
    v_mov_b32 v186, s42
    v_mov_b32 v187, s42
    v_mov_b32 v188, s42
    v_mov_b32 v189, s42
    v_mov_b32 v190, s42
    v_mov_b32 v191, s42
k2_kernel_tv7:
    v_max3_f32 v56, v64, v65, v66
    v_max3_f32 v56, v56, v67, v68
    v_max3_f32 v56, v56, v69, v70
    v_max3_f32 v56, v56, v71, v72
    v_max3_f32 v56, v56, v73, v74
    v_max3_f32 v56, v56, v75, v76
    v_max3_f32 v56, v56, v77, v78
    v_max3_f32 v56, v56, v79, v80
    v_max3_f32 v56, v56, v81, v82
    v_max3_f32 v56, v56, v83, v84
    v_max3_f32 v56, v56, v85, v86
    v_max3_f32 v56, v56, v87, v88
    v_max3_f32 v56, v56, v89, v90
    v_max3_f32 v56, v56, v91, v92
    v_max3_f32 v56, v56, v93, v94
    v_max3_f32 v56, v56, v95, v96
    v_max3_f32 v56, v56, v97, v98
    v_max3_f32 v56, v56, v99, v100
    v_max3_f32 v56, v56, v101, v102
    v_max3_f32 v56, v56, v103, v104
    v_max3_f32 v56, v56, v105, v106
    v_max3_f32 v56, v56, v107, v108
    v_max3_f32 v56, v56, v109, v110
    v_max3_f32 v56, v56, v111, v112
    v_max3_f32 v56, v56, v113, v114
    v_max3_f32 v56, v56, v115, v116
    v_max3_f32 v56, v56, v117, v118
    v_max3_f32 v56, v56, v119, v120
    v_max3_f32 v56, v56, v121, v122
    v_max3_f32 v56, v56, v123, v124
    v_max3_f32 v56, v56, v125, v126
    v_max3_f32 v56, v56, v127, v128
    v_max3_f32 v56, v56, v129, v130
    v_max3_f32 v56, v56, v131, v132
    v_max3_f32 v56, v56, v133, v134
    v_max3_f32 v56, v56, v135, v136
    v_max3_f32 v56, v56, v137, v138
    v_max3_f32 v56, v56, v139, v140
    v_max3_f32 v56, v56, v141, v142
    v_max3_f32 v56, v56, v143, v144
    v_max3_f32 v56, v56, v145, v146
    v_max3_f32 v56, v56, v147, v148
    v_max3_f32 v56, v56, v149, v150
    v_max3_f32 v56, v56, v151, v152
    v_max3_f32 v56, v56, v153, v154
    v_max3_f32 v56, v56, v155, v156
    v_max3_f32 v56, v56, v157, v158
    v_max3_f32 v56, v56, v159, v160
    v_max3_f32 v56, v56, v161, v162
    v_max3_f32 v56, v56, v163, v164
    v_max3_f32 v56, v56, v165, v166
    v_max3_f32 v56, v56, v167, v168
    v_max3_f32 v56, v56, v169, v170
    v_max3_f32 v56, v56, v171, v172
    v_max3_f32 v56, v56, v173, v174
    v_max3_f32 v56, v56, v175, v176
    v_max3_f32 v56, v56, v177, v178
    v_max3_f32 v56, v56, v179, v180
    v_max3_f32 v56, v56, v181, v182
    v_max3_f32 v56, v56, v183, v184
    v_max3_f32 v56, v56, v185, v186
    v_max3_f32 v56, v56, v187, v188
    v_max3_f32 v56, v56, v189, v190
    v_max3_f32 v56, v56, v191, v192
    v_max3_f32 v56, v56, v193, v194
    v_max3_f32 v56, v56, v195, v196
    v_max3_f32 v56, v56, v197, v198
    v_max3_f32 v56, v56, v199, v200
    v_max3_f32 v56, v56, v201, v202
    v_max3_f32 v56, v56, v203, v204
    v_max3_f32 v56, v56, v205, v206
    v_max_f32 v56, v56, v207
    v_mov_b32 v57, v56
    s_nop 1
    v_permlane32_swap_b32 v56, v57
    s_nop 1
    v_max_f32 v56, v56, v57
    s_mov_b32 s43, 0x3fb8aa3b
    v_mul_f32 v56, s43, v56
    v_mov_b32 v57, 0
    v_mov_b32 v58, 0
    v_fma_f32 v64, v64, s43, -v56
    v_exp_f32 v64, v64
    v_fma_f32 v65, v65, s43, -v56
    v_exp_f32 v65, v65
    v_add_f32 v57, v57, v64
    v_fma_f32 v66, v66, s43, -v56
    v_exp_f32 v66, v66
    v_add_f32 v58, v58, v65
    v_fma_f32 v67, v67, s43, -v56
    v_exp_f32 v67, v67
    v_add_f32 v57, v57, v66
    v_fma_f32 v68, v68, s43, -v56
    v_exp_f32 v68, v68
    v_add_f32 v58, v58, v67
    v_fma_f32 v69, v69, s43, -v56
    v_exp_f32 v69, v69
    v_add_f32 v57, v57, v68
    v_fma_f32 v70, v70, s43, -v56
    v_exp_f32 v70, v70
    v_add_f32 v58, v58, v69
    v_fma_f32 v71, v71, s43, -v56
    v_exp_f32 v71, v71
    v_add_f32 v57, v57, v70
    v_fma_f32 v72, v72, s43, -v56
    v_exp_f32 v72, v72
    v_add_f32 v58, v58, v71
    v_fma_f32 v73, v73, s43, -v56
    v_exp_f32 v73, v73
    v_add_f32 v57, v57, v72
    v_fma_f32 v74, v74, s43, -v56
    v_exp_f32 v74, v74
    v_add_f32 v58, v58, v73
    v_fma_f32 v75, v75, s43, -v56
    v_exp_f32 v75, v75
    v_add_f32 v57, v57, v74
    v_fma_f32 v76, v76, s43, -v56
    v_exp_f32 v76, v76
    v_add_f32 v58, v58, v75
    v_fma_f32 v77, v77, s43, -v56
    v_exp_f32 v77, v77
    v_add_f32 v57, v57, v76
    v_fma_f32 v78, v78, s43, -v56
    v_exp_f32 v78, v78
    v_add_f32 v58, v58, v77
    v_fma_f32 v79, v79, s43, -v56
    v_exp_f32 v79, v79
    v_add_f32 v57, v57, v78
    v_fma_f32 v80, v80, s43, -v56
    v_exp_f32 v80, v80
    v_add_f32 v58, v58, v79
    v_fma_f32 v81, v81, s43, -v56
    v_exp_f32 v81, v81
    v_add_f32 v57, v57, v80
    v_fma_f32 v82, v82, s43, -v56
    v_exp_f32 v82, v82
    v_add_f32 v58, v58, v81
    v_fma_f32 v83, v83, s43, -v56
    v_exp_f32 v83, v83
    v_add_f32 v57, v57, v82
    v_fma_f32 v84, v84, s43, -v56
    v_exp_f32 v84, v84
    v_add_f32 v58, v58, v83
    v_fma_f32 v85, v85, s43, -v56
    v_exp_f32 v85, v85
    v_add_f32 v57, v57, v84
    v_fma_f32 v86, v86, s43, -v56
    v_exp_f32 v86, v86
    v_add_f32 v58, v58, v85
    v_fma_f32 v87, v87, s43, -v56
    v_exp_f32 v87, v87
    v_add_f32 v57, v57, v86
    v_fma_f32 v88, v88, s43, -v56
    v_exp_f32 v88, v88
    v_add_f32 v58, v58, v87
    v_fma_f32 v89, v89, s43, -v56
    v_exp_f32 v89, v89
    v_add_f32 v57, v57, v88
    v_fma_f32 v90, v90, s43, -v56
    v_exp_f32 v90, v90
    v_add_f32 v58, v58, v89
    v_fma_f32 v91, v91, s43, -v56
    v_exp_f32 v91, v91
    v_add_f32 v57, v57, v90
    v_fma_f32 v92, v92, s43, -v56
    v_exp_f32 v92, v92
    v_add_f32 v58, v58, v91
    v_fma_f32 v93, v93, s43, -v56
    v_exp_f32 v93, v93
    v_add_f32 v57, v57, v92
    v_fma_f32 v94, v94, s43, -v56
    v_exp_f32 v94, v94
    v_add_f32 v58, v58, v93
    v_fma_f32 v95, v95, s43, -v56
    v_exp_f32 v95, v95
    v_add_f32 v57, v57, v94
    v_fma_f32 v96, v96, s43, -v56
    v_exp_f32 v96, v96
    v_add_f32 v58, v58, v95
    v_fma_f32 v97, v97, s43, -v56
    v_exp_f32 v97, v97
    v_add_f32 v57, v57, v96
    v_fma_f32 v98, v98, s43, -v56
    v_exp_f32 v98, v98
    v_add_f32 v58, v58, v97
    v_fma_f32 v99, v99, s43, -v56
    v_exp_f32 v99, v99
    v_add_f32 v57, v57, v98
    v_fma_f32 v100, v100, s43, -v56
    v_exp_f32 v100, v100
    v_add_f32 v58, v58, v99
    v_fma_f32 v101, v101, s43, -v56
    v_exp_f32 v101, v101
    v_add_f32 v57, v57, v100
    v_fma_f32 v102, v102, s43, -v56
    v_exp_f32 v102, v102
    v_add_f32 v58, v58, v101
    v_fma_f32 v103, v103, s43, -v56
    v_exp_f32 v103, v103
    v_add_f32 v57, v57, v102
    v_fma_f32 v104, v104, s43, -v56
    v_exp_f32 v104, v104
    v_add_f32 v58, v58, v103
    v_fma_f32 v105, v105, s43, -v56
    v_exp_f32 v105, v105
    v_add_f32 v57, v57, v104
    v_fma_f32 v106, v106, s43, -v56
    v_exp_f32 v106, v106
    v_add_f32 v58, v58, v105
    v_fma_f32 v107, v107, s43, -v56
    v_exp_f32 v107, v107
    v_add_f32 v57, v57, v106
    v_fma_f32 v108, v108, s43, -v56
    v_exp_f32 v108, v108
    v_add_f32 v58, v58, v107
    v_fma_f32 v109, v109, s43, -v56
    v_exp_f32 v109, v109
    v_add_f32 v57, v57, v108
    v_fma_f32 v110, v110, s43, -v56
    v_exp_f32 v110, v110
    v_add_f32 v58, v58, v109
    v_fma_f32 v111, v111, s43, -v56
    v_exp_f32 v111, v111
    v_add_f32 v57, v57, v110
    v_fma_f32 v112, v112, s43, -v56
    v_exp_f32 v112, v112
    v_add_f32 v58, v58, v111
    v_fma_f32 v113, v113, s43, -v56
    v_exp_f32 v113, v113
    v_add_f32 v57, v57, v112
    v_fma_f32 v114, v114, s43, -v56
    v_exp_f32 v114, v114
    v_add_f32 v58, v58, v113
    v_fma_f32 v115, v115, s43, -v56
    v_exp_f32 v115, v115
    v_add_f32 v57, v57, v114
    v_fma_f32 v116, v116, s43, -v56
    v_exp_f32 v116, v116
    v_add_f32 v58, v58, v115
    v_fma_f32 v117, v117, s43, -v56
    v_exp_f32 v117, v117
    v_add_f32 v57, v57, v116
    v_fma_f32 v118, v118, s43, -v56
    v_exp_f32 v118, v118
    v_add_f32 v58, v58, v117
    v_fma_f32 v119, v119, s43, -v56
    v_exp_f32 v119, v119
    v_add_f32 v57, v57, v118
    v_fma_f32 v120, v120, s43, -v56
    v_exp_f32 v120, v120
    v_add_f32 v58, v58, v119
    v_fma_f32 v121, v121, s43, -v56
    v_exp_f32 v121, v121
    v_add_f32 v57, v57, v120
    v_fma_f32 v122, v122, s43, -v56
    v_exp_f32 v122, v122
    v_add_f32 v58, v58, v121
    v_fma_f32 v123, v123, s43, -v56
    v_exp_f32 v123, v123
    v_add_f32 v57, v57, v122
    v_fma_f32 v124, v124, s43, -v56
    v_exp_f32 v124, v124
    v_add_f32 v58, v58, v123
    v_fma_f32 v125, v125, s43, -v56
    v_exp_f32 v125, v125
    v_add_f32 v57, v57, v124
    v_fma_f32 v126, v126, s43, -v56
    v_exp_f32 v126, v126
    v_add_f32 v58, v58, v125
    v_fma_f32 v127, v127, s43, -v56
    v_exp_f32 v127, v127
    v_add_f32 v57, v57, v126
    v_fma_f32 v128, v128, s43, -v56
    v_exp_f32 v128, v128
    v_add_f32 v58, v58, v127
    v_fma_f32 v129, v129, s43, -v56
    v_exp_f32 v129, v129
    v_add_f32 v57, v57, v128
    v_fma_f32 v130, v130, s43, -v56
    v_exp_f32 v130, v130
    v_add_f32 v58, v58, v129
    v_fma_f32 v131, v131, s43, -v56
    v_exp_f32 v131, v131
    v_add_f32 v57, v57, v130
    v_fma_f32 v132, v132, s43, -v56
    v_exp_f32 v132, v132
    v_add_f32 v58, v58, v131
    v_fma_f32 v133, v133, s43, -v56
    v_exp_f32 v133, v133
    v_add_f32 v57, v57, v132
    v_fma_f32 v134, v134, s43, -v56
    v_exp_f32 v134, v134
    v_add_f32 v58, v58, v133
    v_fma_f32 v135, v135, s43, -v56
    v_exp_f32 v135, v135
    v_add_f32 v57, v57, v134
    v_fma_f32 v136, v136, s43, -v56
    v_exp_f32 v136, v136
    v_add_f32 v58, v58, v135
    v_fma_f32 v137, v137, s43, -v56
    v_exp_f32 v137, v137
    v_add_f32 v57, v57, v136
    v_fma_f32 v138, v138, s43, -v56
    v_exp_f32 v138, v138
    v_add_f32 v58, v58, v137
    v_fma_f32 v139, v139, s43, -v56
    v_exp_f32 v139, v139
    v_add_f32 v57, v57, v138
    v_fma_f32 v140, v140, s43, -v56
    v_exp_f32 v140, v140
    v_add_f32 v58, v58, v139
    v_fma_f32 v141, v141, s43, -v56
    v_exp_f32 v141, v141
    v_add_f32 v57, v57, v140
    v_fma_f32 v142, v142, s43, -v56
    v_exp_f32 v142, v142
    v_add_f32 v58, v58, v141
    v_fma_f32 v143, v143, s43, -v56
    v_exp_f32 v143, v143
    v_add_f32 v57, v57, v142
    v_fma_f32 v144, v144, s43, -v56
    v_exp_f32 v144, v144
    v_add_f32 v58, v58, v143
    v_fma_f32 v145, v145, s43, -v56
    v_exp_f32 v145, v145
    v_add_f32 v57, v57, v144
    v_fma_f32 v146, v146, s43, -v56
    v_exp_f32 v146, v146
    v_add_f32 v58, v58, v145
    v_fma_f32 v147, v147, s43, -v56
    v_exp_f32 v147, v147
    v_add_f32 v57, v57, v146
    v_fma_f32 v148, v148, s43, -v56
    v_exp_f32 v148, v148
    v_add_f32 v58, v58, v147
    v_fma_f32 v149, v149, s43, -v56
    v_exp_f32 v149, v149
    v_add_f32 v57, v57, v148
    v_fma_f32 v150, v150, s43, -v56
    v_exp_f32 v150, v150
    v_add_f32 v58, v58, v149
    v_fma_f32 v151, v151, s43, -v56
    v_exp_f32 v151, v151
    v_add_f32 v57, v57, v150
    v_fma_f32 v152, v152, s43, -v56
    v_exp_f32 v152, v152
    v_add_f32 v58, v58, v151
    v_fma_f32 v153, v153, s43, -v56
    v_exp_f32 v153, v153
    v_add_f32 v57, v57, v152
    v_fma_f32 v154, v154, s43, -v56
    v_exp_f32 v154, v154
    v_add_f32 v58, v58, v153
    v_fma_f32 v155, v155, s43, -v56
    v_exp_f32 v155, v155
    v_add_f32 v57, v57, v154
    v_fma_f32 v156, v156, s43, -v56
    v_exp_f32 v156, v156
    v_add_f32 v58, v58, v155
    v_fma_f32 v157, v157, s43, -v56
    v_exp_f32 v157, v157
    v_add_f32 v57, v57, v156
    v_fma_f32 v158, v158, s43, -v56
    v_exp_f32 v158, v158
    v_add_f32 v58, v58, v157
    v_fma_f32 v159, v159, s43, -v56
    v_exp_f32 v159, v159
    v_add_f32 v57, v57, v158
    v_fma_f32 v160, v160, s43, -v56
    v_exp_f32 v160, v160
    v_add_f32 v58, v58, v159
    v_fma_f32 v161, v161, s43, -v56
    v_exp_f32 v161, v161
    v_add_f32 v57, v57, v160
    v_fma_f32 v162, v162, s43, -v56
    v_exp_f32 v162, v162
    v_add_f32 v58, v58, v161
    v_fma_f32 v163, v163, s43, -v56
    v_exp_f32 v163, v163
    v_add_f32 v57, v57, v162
    v_fma_f32 v164, v164, s43, -v56
    v_exp_f32 v164, v164
    v_add_f32 v58, v58, v163
    v_fma_f32 v165, v165, s43, -v56
    v_exp_f32 v165, v165
    v_add_f32 v57, v57, v164
    v_fma_f32 v166, v166, s43, -v56
    v_exp_f32 v166, v166
    v_add_f32 v58, v58, v165
    v_fma_f32 v167, v167, s43, -v56
    v_exp_f32 v167, v167
    v_add_f32 v57, v57, v166
    v_fma_f32 v168, v168, s43, -v56
    v_exp_f32 v168, v168
    v_add_f32 v58, v58, v167
    v_fma_f32 v169, v169, s43, -v56
    v_exp_f32 v169, v169
    v_add_f32 v57, v57, v168
    v_fma_f32 v170, v170, s43, -v56
    v_exp_f32 v170, v170
    v_add_f32 v58, v58, v169
    v_fma_f32 v171, v171, s43, -v56
    v_exp_f32 v171, v171
    v_add_f32 v57, v57, v170
    v_fma_f32 v172, v172, s43, -v56
    v_exp_f32 v172, v172
    v_add_f32 v58, v58, v171
    v_fma_f32 v173, v173, s43, -v56
    v_exp_f32 v173, v173
    v_add_f32 v57, v57, v172
    v_fma_f32 v174, v174, s43, -v56
    v_exp_f32 v174, v174
    v_add_f32 v58, v58, v173
    v_fma_f32 v175, v175, s43, -v56
    v_exp_f32 v175, v175
    v_add_f32 v57, v57, v174
    v_fma_f32 v176, v176, s43, -v56
    v_exp_f32 v176, v176
    v_add_f32 v58, v58, v175
    v_fma_f32 v177, v177, s43, -v56
    v_exp_f32 v177, v177
    v_add_f32 v57, v57, v176
    v_fma_f32 v178, v178, s43, -v56
    v_exp_f32 v178, v178
    v_add_f32 v58, v58, v177
    v_fma_f32 v179, v179, s43, -v56
    v_exp_f32 v179, v179
    v_add_f32 v57, v57, v178
    v_fma_f32 v180, v180, s43, -v56
    v_exp_f32 v180, v180
    v_add_f32 v58, v58, v179
    v_fma_f32 v181, v181, s43, -v56
    v_exp_f32 v181, v181
    v_add_f32 v57, v57, v180
    v_fma_f32 v182, v182, s43, -v56
    v_exp_f32 v182, v182
    v_add_f32 v58, v58, v181
    v_fma_f32 v183, v183, s43, -v56
    v_exp_f32 v183, v183
    v_add_f32 v57, v57, v182
    v_fma_f32 v184, v184, s43, -v56
    v_exp_f32 v184, v184
    v_add_f32 v58, v58, v183
    v_fma_f32 v185, v185, s43, -v56
    v_exp_f32 v185, v185
    v_add_f32 v57, v57, v184
    v_fma_f32 v186, v186, s43, -v56
    v_exp_f32 v186, v186
    v_add_f32 v58, v58, v185
    v_fma_f32 v187, v187, s43, -v56
    v_exp_f32 v187, v187
    v_add_f32 v57, v57, v186
    v_fma_f32 v188, v188, s43, -v56
    v_exp_f32 v188, v188
    v_add_f32 v58, v58, v187
    v_fma_f32 v189, v189, s43, -v56
    v_exp_f32 v189, v189
    v_add_f32 v57, v57, v188
    v_fma_f32 v190, v190, s43, -v56
    v_exp_f32 v190, v190
    v_add_f32 v58, v58, v189
    v_fma_f32 v191, v191, s43, -v56
    v_exp_f32 v191, v191
    v_add_f32 v57, v57, v190
    v_fma_f32 v192, v192, s43, -v56
    v_exp_f32 v192, v192
    v_add_f32 v58, v58, v191
    v_fma_f32 v193, v193, s43, -v56
    v_exp_f32 v193, v193
    v_add_f32 v57, v57, v192
    v_fma_f32 v194, v194, s43, -v56
    v_exp_f32 v194, v194
    v_add_f32 v58, v58, v193
    v_fma_f32 v195, v195, s43, -v56
    v_exp_f32 v195, v195
    v_add_f32 v57, v57, v194
    v_fma_f32 v196, v196, s43, -v56
    v_exp_f32 v196, v196
    v_add_f32 v58, v58, v195
    v_fma_f32 v197, v197, s43, -v56
    v_exp_f32 v197, v197
    v_add_f32 v57, v57, v196
    v_fma_f32 v198, v198, s43, -v56
    v_exp_f32 v198, v198
    v_add_f32 v58, v58, v197
    v_fma_f32 v199, v199, s43, -v56
    v_exp_f32 v199, v199
    v_add_f32 v57, v57, v198
    v_fma_f32 v200, v200, s43, -v56
    v_exp_f32 v200, v200
    v_add_f32 v58, v58, v199
    v_fma_f32 v201, v201, s43, -v56
    v_exp_f32 v201, v201
    v_add_f32 v57, v57, v200
    v_fma_f32 v202, v202, s43, -v56
    v_exp_f32 v202, v202
    v_add_f32 v58, v58, v201
    v_fma_f32 v203, v203, s43, -v56
    v_exp_f32 v203, v203
    v_add_f32 v57, v57, v202
    v_fma_f32 v204, v204, s43, -v56
    v_exp_f32 v204, v204
    v_add_f32 v58, v58, v203
    v_fma_f32 v205, v205, s43, -v56
    v_exp_f32 v205, v205
    v_add_f32 v57, v57, v204
    v_fma_f32 v206, v206, s43, -v56
    v_exp_f32 v206, v206
    v_add_f32 v58, v58, v205
    v_fma_f32 v207, v207, s43, -v56
    v_exp_f32 v207, v207
    v_add_f32 v57, v57, v206
    s_nop 0
    v_add_f32 v58, v58, v207
    v_add_f32 v57, v57, v58
    v_mov_b32 v58, v57
    s_nop 1
    v_permlane32_swap_b32 v57, v58
    s_nop 1
    v_add_f32 v57, v57, v58
    v_rcp_f32 v57, v57
    s_nop 0
    v_mul_f32 v64, v64, v57
    v_mul_f32 v65, v65, v57
    v_cvt_pk_bf16_f32 v64, v64, v65
    v_mul_f32 v66, v66, v57
    v_mul_f32 v67, v67, v57
    v_cvt_pk_bf16_f32 v65, v66, v67
    v_mul_f32 v68, v68, v57
    v_mul_f32 v69, v69, v57
    v_cvt_pk_bf16_f32 v66, v68, v69
    v_mul_f32 v70, v70, v57
    v_mul_f32 v71, v71, v57
    v_cvt_pk_bf16_f32 v67, v70, v71
    v_mul_f32 v72, v72, v57
    v_mul_f32 v73, v73, v57
    v_cvt_pk_bf16_f32 v68, v72, v73
    v_mul_f32 v74, v74, v57
    v_mul_f32 v75, v75, v57
    v_cvt_pk_bf16_f32 v69, v74, v75
    v_mul_f32 v76, v76, v57
    v_mul_f32 v77, v77, v57
    v_cvt_pk_bf16_f32 v70, v76, v77
    v_mul_f32 v78, v78, v57
    v_mul_f32 v79, v79, v57
    v_cvt_pk_bf16_f32 v71, v78, v79
    s_waitcnt vmcnt(4)
    v_mfma_f32_32x32x16_bf16 v[40:55], v[208:211], v[64:67], 0
    v_mfma_f32_32x32x16_bf16 v[40:55], v[212:215], v[68:71], v[40:55]
    s_cmp_lt_u32 s31, 160
    s_cselect_b32 s47, 0x7f000000, s39
    buffer_load_dwordx4 v[208:211], v5, s[24:27], s47 offen
    buffer_load_dwordx4 v[212:215], v5, s[24:27], s47 offen offset:16
    s_add_u32 s39, s39, 1280
    v_mul_f32 v80, v80, v57
    v_mul_f32 v81, v81, v57
    v_cvt_pk_bf16_f32 v80, v80, v81
    v_mul_f32 v82, v82, v57
    v_mul_f32 v83, v83, v57
    v_cvt_pk_bf16_f32 v81, v82, v83
    v_mul_f32 v84, v84, v57
    v_mul_f32 v85, v85, v57
    v_cvt_pk_bf16_f32 v82, v84, v85
    v_mul_f32 v86, v86, v57
    v_mul_f32 v87, v87, v57
    v_cvt_pk_bf16_f32 v83, v86, v87
    v_mul_f32 v88, v88, v57
    v_mul_f32 v89, v89, v57
    v_cvt_pk_bf16_f32 v84, v88, v89
    v_mul_f32 v90, v90, v57
    v_mul_f32 v91, v91, v57
    v_cvt_pk_bf16_f32 v85, v90, v91
    v_mul_f32 v92, v92, v57
    v_mul_f32 v93, v93, v57
    v_cvt_pk_bf16_f32 v86, v92, v93
    v_mul_f32 v94, v94, v57
    v_mul_f32 v95, v95, v57
    v_cvt_pk_bf16_f32 v87, v94, v95
    s_waitcnt vmcnt(4)
    v_mfma_f32_32x32x16_bf16 v[40:55], v[216:219], v[80:83], v[40:55]
    v_mfma_f32_32x32x16_bf16 v[40:55], v[220:223], v[84:87], v[40:55]
    s_cmp_lt_u32 s31, 128
    s_cselect_b32 s47, 0x7f000000, s39
    buffer_load_dwordx4 v[216:219], v5, s[24:27], s47 offen
    buffer_load_dwordx4 v[220:223], v5, s[24:27], s47 offen offset:16
    s_add_u32 s39, s39, 1280
    v_mul_f32 v96, v96, v57
    v_mul_f32 v97, v97, v57
    v_cvt_pk_bf16_f32 v96, v96, v97
    v_mul_f32 v98, v98, v57
    v_mul_f32 v99, v99, v57
    v_cvt_pk_bf16_f32 v97, v98, v99
    v_mul_f32 v100, v100, v57
    v_mul_f32 v101, v101, v57
    v_cvt_pk_bf16_f32 v98, v100, v101
    v_mul_f32 v102, v102, v57
    v_mul_f32 v103, v103, v57
    v_cvt_pk_bf16_f32 v99, v102, v103
    v_mul_f32 v104, v104, v57
    v_mul_f32 v105, v105, v57
    v_cvt_pk_bf16_f32 v100, v104, v105
    v_mul_f32 v106, v106, v57
    v_mul_f32 v107, v107, v57
    v_cvt_pk_bf16_f32 v101, v106, v107
    v_mul_f32 v108, v108, v57
    v_mul_f32 v109, v109, v57
    v_cvt_pk_bf16_f32 v102, v108, v109
    v_mul_f32 v110, v110, v57
    v_mul_f32 v111, v111, v57
    v_cvt_pk_bf16_f32 v103, v110, v111
    s_waitcnt vmcnt(4)
    v_mfma_f32_32x32x16_bf16 v[40:55], v[224:227], v[96:99], v[40:55]
    v_mfma_f32_32x32x16_bf16 v[40:55], v[228:231], v[100:103], v[40:55]
    s_cmp_lt_u32 s31, 96
    s_cselect_b32 s47, 0x7f000000, s39
    buffer_load_dwordx4 v[224:227], v5, s[24:27], s47 offen
    buffer_load_dwordx4 v[228:231], v5, s[24:27], s47 offen offset:16
    s_add_u32 s39, s39, 1280
    v_mul_f32 v112, v112, v57
    v_mul_f32 v113, v113, v57
    v_cvt_pk_bf16_f32 v112, v112, v113
    v_mul_f32 v114, v114, v57
    v_mul_f32 v115, v115, v57
    v_cvt_pk_bf16_f32 v113, v114, v115
    v_mul_f32 v116, v116, v57
    v_mul_f32 v117, v117, v57
    v_cvt_pk_bf16_f32 v114, v116, v117
    v_mul_f32 v118, v118, v57
    v_mul_f32 v119, v119, v57
    v_cvt_pk_bf16_f32 v115, v118, v119
    v_mul_f32 v120, v120, v57
    v_mul_f32 v121, v121, v57
    v_cvt_pk_bf16_f32 v116, v120, v121
    v_mul_f32 v122, v122, v57
    v_mul_f32 v123, v123, v57
    v_cvt_pk_bf16_f32 v117, v122, v123
    v_mul_f32 v124, v124, v57
    v_mul_f32 v125, v125, v57
    v_cvt_pk_bf16_f32 v118, v124, v125
    v_mul_f32 v126, v126, v57
    v_mul_f32 v127, v127, v57
    v_cvt_pk_bf16_f32 v119, v126, v127
    s_waitcnt vmcnt(4)
    v_mfma_f32_32x32x16_bf16 v[40:55], v[208:211], v[112:115], v[40:55]
    v_mfma_f32_32x32x16_bf16 v[40:55], v[212:215], v[116:119], v[40:55]
    s_cmp_lt_u32 s31, 64
    s_cselect_b32 s47, 0x7f000000, s39
    buffer_load_dwordx4 v[208:211], v5, s[24:27], s47 offen
    buffer_load_dwordx4 v[212:215], v5, s[24:27], s47 offen offset:16
    s_add_u32 s39, s39, 1280
    v_mul_f32 v128, v128, v57
    v_mul_f32 v129, v129, v57
    v_cvt_pk_bf16_f32 v128, v128, v129
    v_mul_f32 v130, v130, v57
    v_mul_f32 v131, v131, v57
    v_cvt_pk_bf16_f32 v129, v130, v131
    v_mul_f32 v132, v132, v57
    v_mul_f32 v133, v133, v57
    v_cvt_pk_bf16_f32 v130, v132, v133
    v_mul_f32 v134, v134, v57
    v_mul_f32 v135, v135, v57
    v_cvt_pk_bf16_f32 v131, v134, v135
    v_mul_f32 v136, v136, v57
    v_mul_f32 v137, v137, v57
    v_cvt_pk_bf16_f32 v132, v136, v137
    v_mul_f32 v138, v138, v57
    v_mul_f32 v139, v139, v57
    v_cvt_pk_bf16_f32 v133, v138, v139
    v_mul_f32 v140, v140, v57
    v_mul_f32 v141, v141, v57
    v_cvt_pk_bf16_f32 v134, v140, v141
    v_mul_f32 v142, v142, v57
    v_mul_f32 v143, v143, v57
    v_cvt_pk_bf16_f32 v135, v142, v143
    s_waitcnt vmcnt(4)
    v_mfma_f32_32x32x16_bf16 v[40:55], v[216:219], v[128:131], v[40:55]
    v_mfma_f32_32x32x16_bf16 v[40:55], v[220:223], v[132:135], v[40:55]
    s_cmp_lt_u32 s31, 32
    s_cselect_b32 s47, 0x7f000000, s39
    buffer_load_dwordx4 v[216:219], v5, s[24:27], s47 offen
    buffer_load_dwordx4 v[220:223], v5, s[24:27], s47 offen offset:16
    s_add_u32 s39, s39, 1280
    v_mul_f32 v144, v144, v57
    v_mul_f32 v145, v145, v57
    v_cvt_pk_bf16_f32 v144, v144, v145
    v_mul_f32 v146, v146, v57
    v_mul_f32 v147, v147, v57
    v_cvt_pk_bf16_f32 v145, v146, v147
    v_mul_f32 v148, v148, v57
    v_mul_f32 v149, v149, v57
    v_cvt_pk_bf16_f32 v146, v148, v149
    v_mul_f32 v150, v150, v57
    v_mul_f32 v151, v151, v57
    v_cvt_pk_bf16_f32 v147, v150, v151
    v_mul_f32 v152, v152, v57
    v_mul_f32 v153, v153, v57
    v_cvt_pk_bf16_f32 v148, v152, v153
    v_mul_f32 v154, v154, v57
    v_mul_f32 v155, v155, v57
    v_cvt_pk_bf16_f32 v149, v154, v155
    v_mul_f32 v156, v156, v57
    v_mul_f32 v157, v157, v57
    v_cvt_pk_bf16_f32 v150, v156, v157
    v_mul_f32 v158, v158, v57
    v_mul_f32 v159, v159, v57
    v_cvt_pk_bf16_f32 v151, v158, v159
    s_waitcnt vmcnt(4)
    v_mfma_f32_32x32x16_bf16 v[40:55], v[224:227], v[144:147], v[40:55]
    v_mfma_f32_32x32x16_bf16 v[40:55], v[228:231], v[148:151], v[40:55]
    s_cmp_lt_u32 s31, 0
    s_cselect_b32 s47, 0x7f000000, s39
    buffer_load_dwordx4 v[224:227], v5, s[24:27], s47 offen
    buffer_load_dwordx4 v[228:231], v5, s[24:27], s47 offen offset:16
    s_add_u32 s39, s39, 1280
    v_mul_f32 v160, v160, v57
    v_mul_f32 v161, v161, v57
    v_cvt_pk_bf16_f32 v160, v160, v161
    v_mul_f32 v162, v162, v57
    v_mul_f32 v163, v163, v57
    v_cvt_pk_bf16_f32 v161, v162, v163
    v_mul_f32 v164, v164, v57
    v_mul_f32 v165, v165, v57
    v_cvt_pk_bf16_f32 v162, v164, v165
    v_mul_f32 v166, v166, v57
    v_mul_f32 v167, v167, v57
    v_cvt_pk_bf16_f32 v163, v166, v167
    v_mul_f32 v168, v168, v57
    v_mul_f32 v169, v169, v57
    v_cvt_pk_bf16_f32 v164, v168, v169
    v_mul_f32 v170, v170, v57
    v_mul_f32 v171, v171, v57
    v_cvt_pk_bf16_f32 v165, v170, v171
    v_mul_f32 v172, v172, v57
    v_mul_f32 v173, v173, v57
    v_cvt_pk_bf16_f32 v166, v172, v173
    v_mul_f32 v174, v174, v57
    v_mul_f32 v175, v175, v57
    v_cvt_pk_bf16_f32 v167, v174, v175
    s_waitcnt vmcnt(4)
    v_mfma_f32_32x32x16_bf16 v[40:55], v[208:211], v[160:163], v[40:55]
    v_mfma_f32_32x32x16_bf16 v[40:55], v[212:215], v[164:167], v[40:55]
    v_mul_f32 v176, v176, v57
    v_mul_f32 v177, v177, v57
    v_cvt_pk_bf16_f32 v176, v176, v177
    v_mul_f32 v178, v178, v57
    v_mul_f32 v179, v179, v57
    v_cvt_pk_bf16_f32 v177, v178, v179
    v_mul_f32 v180, v180, v57
    v_mul_f32 v181, v181, v57
    v_cvt_pk_bf16_f32 v178, v180, v181
    v_mul_f32 v182, v182, v57
    v_mul_f32 v183, v183, v57
    v_cvt_pk_bf16_f32 v179, v182, v183
    v_mul_f32 v184, v184, v57
    v_mul_f32 v185, v185, v57
    v_cvt_pk_bf16_f32 v180, v184, v185
    v_mul_f32 v186, v186, v57
    v_mul_f32 v187, v187, v57
    v_cvt_pk_bf16_f32 v181, v186, v187
    v_mul_f32 v188, v188, v57
    v_mul_f32 v189, v189, v57
    v_cvt_pk_bf16_f32 v182, v188, v189
    v_mul_f32 v190, v190, v57
    v_mul_f32 v191, v191, v57
    v_cvt_pk_bf16_f32 v183, v190, v191
    s_waitcnt vmcnt(2)
    v_mfma_f32_32x32x16_bf16 v[40:55], v[216:219], v[176:179], v[40:55]
    v_mfma_f32_32x32x16_bf16 v[40:55], v[220:223], v[180:183], v[40:55]
    v_mul_f32 v192, v192, v57
    v_mul_f32 v193, v193, v57
    v_cvt_pk_bf16_f32 v192, v192, v193
    v_mul_f32 v194, v194, v57
    v_mul_f32 v195, v195, v57
    v_cvt_pk_bf16_f32 v193, v194, v195
    v_mul_f32 v196, v196, v57
    v_mul_f32 v197, v197, v57
    v_cvt_pk_bf16_f32 v194, v196, v197
    v_mul_f32 v198, v198, v57
    v_mul_f32 v199, v199, v57
    v_cvt_pk_bf16_f32 v195, v198, v199
    v_mul_f32 v200, v200, v57
    v_mul_f32 v201, v201, v57
    v_cvt_pk_bf16_f32 v196, v200, v201
    v_mul_f32 v202, v202, v57
    v_mul_f32 v203, v203, v57
    v_cvt_pk_bf16_f32 v197, v202, v203
    v_mul_f32 v204, v204, v57
    v_mul_f32 v205, v205, v57
    v_cvt_pk_bf16_f32 v198, v204, v205
    v_mul_f32 v206, v206, v57
    v_mul_f32 v207, v207, v57
    v_cvt_pk_bf16_f32 v199, v206, v207
    s_waitcnt vmcnt(0)
    v_mfma_f32_32x32x16_bf16 v[40:55], v[224:227], v[192:195], v[40:55]
    v_mfma_f32_32x32x16_bf16 v[40:55], v[228:231], v[196:199], v[40:55]
    s_nop 7
    s_nop 7
    v_add_u32 v56, s31, v2
    s_movk_i32 s33, 1280
    v_mul_lo_u32 v56, v56, s33
    v_lshlrev_b32 v57, 3, v3
    v_add_u32 v56, v56, v57
    s_add_u32 s34, s34, 16777216
    v_cvt_pk_bf16_f32 v58, v40, v41
    v_cvt_pk_bf16_f32 v59, v42, v43
    v_cvt_pk_bf16_f32 v60, v44, v45
    v_cvt_pk_bf16_f32 v61, v46, v47
    v_cvt_pk_bf16_f32 v62, v48, v49
    v_cvt_pk_bf16_f32 v63, v50, v51
    buffer_store_dwordx2 v[58:59], v56, s[24:27], s34 offen
    buffer_store_dwordx2 v[60:61], v56, s[24:27], s34 offen offset:16
    v_cmp_gt_u32 vcc, 32, v1
    s_and_saveexec_b64 s[44:45], vcc
    buffer_store_dwordx2 v[62:63], v56, s[24:27], s34 offen offset:32
    s_mov_b64 exec, s[44:45]
k2_kernel_end:
    s_endpgm

.section .rodata,"a"
.p2align 6
.amdhsa_kernel k2_kernel
  .amdhsa_next_free_vgpr 232
  .amdhsa_next_free_sgpr 64
  .amdhsa_accum_offset 232
  .amdhsa_group_segment_fixed_size 0
  .amdhsa_kernarg_size 88
  .amdhsa_user_sgpr_count 2
  .amdhsa_user_sgpr_kernarg_segment_ptr 1
  .amdhsa_system_sgpr_workgroup_id_x 1
.end_amdhsa_kernel
.text
.globl k3_kernel
.p2align 8
.type k3_kernel,@function
k3_kernel:
    s_cmp_ge_u32 s2, 256
    s_cbranch_scc1 k3_kernel_end
    s_load_dwordx2 s[4:5], s[0:1], 16
    s_load_dwordx2 s[6:7], s[0:1], 48
    s_load_dwordx2 s[8:9], s[0:1], 64
    s_load_dwordx2 s[12:13], s[0:1], 80
    v_and_b32 v1, 63, v0
    v_lshrrev_b32 v2, 6, v0
    s_and_b32 s28, s2, 7
    s_lshl_b32 s28, s28, 2
    s_bfe_u32 s29, s2, 0x20003
    s_add_u32 s28, s28, s29
    s_lshr_b32 s29, s2, 5
    v_readfirstlane_b32 s30, v2
    s_nop 3
    s_waitcnt lgkmcnt(0)
    s_mov_b32 s16, s4
    s_and_b32 s17, s5, 0xffff
    s_mov_b32 s18, 819200
    s_mov_b32 s19, 0x00020000
    s_mov_b32 s20, s6
    s_and_b32 s21, s7, 0xffff
    s_mov_b32 s22, 2211840
    s_mov_b32 s23, 0x00020000
    s_mov_b32 s24, s12
    s_and_b32 s25, s13, 0xffff
    s_mov_b32 s26, 25165824
    s_mov_b32 s27, 0x00020000
    s_mov_b32 s36, s8
    s_and_b32 s37, s9, 0xffff
    s_mov_b32 s38, 2621440
    s_mov_b32 s39, 0x00020000
    s_mul_i32 s31, s29, 160
    s_mov_b32 s32, 0x19999a
    v_lshlrev_b32 v10, 4, v1
    v_add_u32 v10, 0, v10
    v_lshrrev_b32 v11, 5, v10
    v_mul_u32_u24 v11, s32, v11
    v_lshrrev_b32 v11, 23, v11
    v_mul_u32_u24 v12, 160, v11
    v_sub_u32 v12, v10, v12
    v_mul_u32_u24 v11, 1280, v11
    v_add_u32 v11, v11, v12
    v_add_u32 v4, s31, v11
    v_lshlrev_b32 v10, 4, v1
    v_add_u32 v10, 1024, v10
    v_lshrrev_b32 v11, 5, v10
    v_mul_u32_u24 v11, s32, v11
    v_lshrrev_b32 v11, 23, v11
    v_mul_u32_u24 v12, 160, v11
    v_sub_u32 v12, v10, v12
    v_mul_u32_u24 v11, 1280, v11
    v_add_u32 v11, v11, v12
    v_add_u32 v5, s31, v11
    v_lshlrev_b32 v10, 4, v1
    v_add_u32 v10, 2048, v10
    v_lshrrev_b32 v11, 5, v10
    v_mul_u32_u24 v11, s32, v11
    v_lshrrev_b32 v11, 23, v11
    v_mul_u32_u24 v12, 160, v11
    v_sub_u32 v12, v10, v12
    v_mul_u32_u24 v11, 1280, v11
    v_add_u32 v11, v11, v12
    v_add_u32 v6, s31, v11
    v_lshlrev_b32 v10, 4, v1
    v_add_u32 v10, 3072, v10
    v_lshrrev_b32 v11, 5, v10
    v_mul_u32_u24 v11, s32, v11
    v_lshrrev_b32 v11, 23, v11
    v_mul_u32_u24 v12, 160, v11
    v_sub_u32 v12, v10, v12
    v_mul_u32_u24 v11, 1280, v11
    v_add_u32 v11, v11, v12
    v_add_u32 v7, s31, v11
    v_lshlrev_b32 v10, 4, v1
    v_add_u32 v10, 4096, v10
    v_lshrrev_b32 v11, 5, v10
    v_mul_u32_u24 v11, s32, v11
    v_lshrrev_b32 v11, 23, v11
    v_mul_u32_u24 v12, 160, v11
    v_sub_u32 v12, v10, v12
    v_mul_u32_u24 v11, 1280, v11
    v_add_u32 v11, v11, v12
    v_add_u32 v8, s31, v11
    s_lshl_b32 s33, s28, 6
    v_and_b32 v11, 15, v1
    v_add_u32 v11, s33, v11
    v_lshrrev_b32 v12, 4, v1
    v_lshlrev_b32 v12, 4, v12
    v_mul_u32_u24 v9, 1280, v11
    v_add_u32 v9, v9, v12
    v_add_u32 v9, 16777216, v9
    v_mul_u32_u24 v10, 3456, v11
    v_add_u32 v10, v10, v12
    v_add_u32 v10, 8388608, v10
    v_lshrrev_b32 v12, 4, v1
    v_lshlrev_b32 v12, 3, v12
    v_bfe_u32 v13, v1, 2, 2
    v_add_u32 v12, v12, v13
    v_mul_u32_u24 v12, 160, v12
    v_and_b32 v13, 3, v1
    v_lshlrev_b32 v13, 3, v13
    v_add_u32 v12, v12, v13
    s_mul_i32 s34, s30, 20480
    v_add_u32 v11, s34, v12
    s_mul_i32 s40, s30, 40960
    s_lshl_b32 s41, s30, 6
    s_add_u32 m0, s34, 0
    s_nop 0
    buffer_load_dwordx4 v4, s[16:19], s40 offen lds
    s_add_u32 m0, s34, 1024
    s_nop 0
    buffer_load_dwordx4 v5, s[16:19], s40 offen lds
    s_add_u32 m0, s34, 2048
    s_nop 0
    buffer_load_dwordx4 v6, s[16:19], s40 offen lds
    s_add_u32 m0, s34, 3072
    s_nop 0
    buffer_load_dwordx4 v7, s[16:19], s40 offen lds
    s_add_u32 m0, s34, 4096
    s_nop 0
    buffer_load_dwordx4 v8, s[16:19], s40 offen lds
    s_add_u32 s42, s41, 0
    buffer_load_dwordx4 v[16:19], v9, s[24:27], s42 offen
    s_add_u32 s42, s41, 20480
    buffer_load_dwordx4 v[20:23], v9, s[24:27], s42 offen
    s_add_u32 s42, s41, 40960
    buffer_load_dwordx4 v[24:27], v9, s[24:27], s42 offen
    s_add_u32 s42, s41, 61440
    buffer_load_dwordx4 v[28:31], v9, s[24:27], s42 offen
    s_add_u32 s40, s40, 163840
    s_add_u32 s41, s41, 256
    s_add_u32 m0, s34, 5120
    s_nop 0
    buffer_load_dwordx4 v4, s[16:19], s40 offen lds
    s_add_u32 m0, s34, 6144
    s_nop 0
    buffer_load_dwordx4 v5, s[16:19], s40 offen lds
    s_add_u32 m0, s34, 7168
    s_nop 0
    buffer_load_dwordx4 v6, s[16:19], s40 offen lds
    s_add_u32 m0, s34, 8192
    s_nop 0
    buffer_load_dwordx4 v7, s[16:19], s40 offen lds
    s_add_u32 m0, s34, 9216
    s_nop 0
    buffer_load_dwordx4 v8, s[16:19], s40 offen lds
    s_add_u32 s42, s41, 0
    buffer_load_dwordx4 v[32:35], v9, s[24:27], s42 offen
    s_add_u32 s42, s41, 20480
    buffer_load_dwordx4 v[36:39], v9, s[24:27], s42 offen
    s_add_u32 s42, s41, 40960
    buffer_load_dwordx4 v[40:43], v9, s[24:27], s42 offen
    s_add_u32 s42, s41, 61440
    buffer_load_dwordx4 v[44:47], v9, s[24:27], s42 offen
    s_add_u32 s40, s40, 163840
    s_add_u32 s41, s41, 256
    s_add_u32 m0, s34, 10240
    s_nop 0
    buffer_load_dwordx4 v4, s[16:19], s40 offen lds
    s_add_u32 m0, s34, 11264
    s_nop 0
    buffer_load_dwordx4 v5, s[16:19], s40 offen lds
    s_add_u32 m0, s34, 12288
    s_nop 0
    buffer_load_dwordx4 v6, s[16:19], s40 offen lds
    s_add_u32 m0, s34, 13312
    s_nop 0
    buffer_load_dwordx4 v7, s[16:19], s40 offen lds
    s_add_u32 m0, s34, 14336
    s_nop 0
    buffer_load_dwordx4 v8, s[16:19], s40 offen lds
    s_add_u32 s42, s41, 0
    buffer_load_dwordx4 v[48:51], v9, s[24:27], s42 offen
    s_add_u32 s42, s41, 20480
    buffer_load_dwordx4 v[52:55], v9, s[24:27], s42 offen
    s_add_u32 s42, s41, 40960
    buffer_load_dwordx4 v[56:59], v9, s[24:27], s42 offen
    s_add_u32 s42, s41, 61440
    buffer_load_dwordx4 v[60:63], v9, s[24:27], s42 offen
    s_add_u32 s40, s40, 163840
    s_add_u32 s41, s41, 256
    s_waitcnt vmcnt(18)
    ds_read_b64_tr_b16 v[224:225], v11 offset:0
    ds_read_b64_tr_b16 v[226:227], v11 offset:640
    ds_read_b64_tr_b16 v[228:229], v11 offset:32
    ds_read_b64_tr_b16 v[230:231], v11 offset:672
    ds_read_b64_tr_b16 v[232:233], v11 offset:64
    ds_read_b64_tr_b16 v[234:235], v11 offset:704
    ds_read_b64_tr_b16 v[236:237], v11 offset:96
    ds_read_b64_tr_b16 v[238:239], v11 offset:736
    ds_read_b64_tr_b16 v[240:241], v11 offset:128
    ds_read_b64_tr_b16 v[242:243], v11 offset:768
    s_waitcnt lgkmcnt(8)
    v_mfma_f32_16x16x32_bf16 v[64:67], v[224:227], v[16:19], 0
    v_mfma_f32_16x16x32_bf16 v[68:71], v[224:227], v[20:23], 0
    v_mfma_f32_16x16x32_bf16 v[72:75], v[224:227], v[24:27], 0
    v_mfma_f32_16x16x32_bf16 v[76:79], v[224:227], v[28:31], 0
    s_waitcnt lgkmcnt(6)
    v_mfma_f32_16x16x32_bf16 v[80:83], v[228:231], v[16:19], 0
    v_mfma_f32_16x16x32_bf16 v[84:87], v[228:231], v[20:23], 0
    v_mfma_f32_16x16x32_bf16 v[88:91], v[228:231], v[24:27], 0
    v_mfma_f32_16x16x32_bf16 v[92:95], v[228:231], v[28:31], 0
    s_waitcnt lgkmcnt(4)
    v_mfma_f32_16x16x32_bf16 v[96:99], v[232:235], v[16:19], 0
    v_mfma_f32_16x16x32_bf16 v[100:103], v[232:235], v[20:23], 0
    v_mfma_f32_16x16x32_bf16 v[104:107], v[232:235], v[24:27], 0
    v_mfma_f32_16x16x32_bf16 v[108:111], v[232:235], v[28:31], 0
    s_waitcnt lgkmcnt(2)
    v_mfma_f32_16x16x32_bf16 v[112:115], v[236:239], v[16:19], 0
    v_mfma_f32_16x16x32_bf16 v[116:119], v[236:239], v[20:23], 0
    v_mfma_f32_16x16x32_bf16 v[120:123], v[236:239], v[24:27], 0
    v_mfma_f32_16x16x32_bf16 v[124:127], v[236:239], v[28:31], 0
    s_waitcnt lgkmcnt(0)
    v_mfma_f32_16x16x32_bf16 v[128:131], v[240:243], v[16:19], 0
    v_mfma_f32_16x16x32_bf16 v[132:135], v[240:243], v[20:23], 0
    v_mfma_f32_16x16x32_bf16 v[136:139], v[240:243], v[24:27], 0
    v_mfma_f32_16x16x32_bf16 v[140:143], v[240:243], v[28:31], 0
    s_add_u32 m0, s34, 15360
    s_nop 0
    buffer_load_dwordx4 v4, s[16:19], s40 offen lds
    s_add_u32 m0, s34, 16384
    s_nop 0
    buffer_load_dwordx4 v5, s[16:19], s40 offen lds
    s_add_u32 m0, s34, 17408
    s_nop 0
    buffer_load_dwordx4 v6, s[16:19], s40 offen lds
    s_add_u32 m0, s34, 18432
    s_nop 0
    buffer_load_dwordx4 v7, s[16:19], s40 offen lds
    s_add_u32 m0, s34, 19456
    s_nop 0
    buffer_load_dwordx4 v8, s[16:19], s40 offen lds
    s_add_u32 s42, s41, 0
    buffer_load_dwordx4 v[16:19], v9, s[24:27], s42 offen
    s_add_u32 s42, s41, 20480
    buffer_load_dwordx4 v[20:23], v9, s[24:27], s42 offen
    s_add_u32 s42, s41, 40960
    buffer_load_dwordx4 v[24:27], v9, s[24:27], s42 offen
    s_add_u32 s42, s41, 61440
    buffer_load_dwordx4 v[28:31], v9, s[24:27], s42 offen
    s_add_u32 s40, s40, 163840
    s_add_u32 s41, s41, 256
    s_waitcnt vmcnt(18)
    ds_read_b64_tr_b16 v[224:225], v11 offset:5120
    ds_read_b64_tr_b16 v[226:227], v11 offset:5760
    ds_read_b64_tr_b16 v[228:229], v11 offset:5152
    ds_read_b64_tr_b16 v[230:231], v11 offset:5792
    ds_read_b64_tr_b16 v[232:233], v11 offset:5184
    ds_read_b64_tr_b16 v[234:235], v11 offset:5824
    ds_read_b64_tr_b16 v[236:237], v11 offset:5216
    ds_read_b64_tr_b16 v[238:239], v11 offset:5856
    ds_read_b64_tr_b16 v[240:241], v11 offset:5248
    ds_read_b64_tr_b16 v[242:243], v11 offset:5888
    s_waitcnt lgkmcnt(8)
    v_mfma_f32_16x16x32_bf16 v[64:67], v[224:227], v[32:35], v[64:67]
    v_mfma_f32_16x16x32_bf16 v[68:71], v[224:227], v[36:39], v[68:71]
    v_mfma_f32_16x16x32_bf16 v[72:75], v[224:227], v[40:43], v[72:75]
    v_mfma_f32_16x16x32_bf16 v[76:79], v[224:227], v[44:47], v[76:79]
    s_waitcnt lgkmcnt(6)
    v_mfma_f32_16x16x32_bf16 v[80:83], v[228:231], v[32:35], v[80:83]
    v_mfma_f32_16x16x32_bf16 v[84:87], v[228:231], v[36:39], v[84:87]
    v_mfma_f32_16x16x32_bf16 v[88:91], v[228:231], v[40:43], v[88:91]
    v_mfma_f32_16x16x32_bf16 v[92:95], v[228:231], v[44:47], v[92:95]
    s_waitcnt lgkmcnt(4)
    v_mfma_f32_16x16x32_bf16 v[96:99], v[232:235], v[32:35], v[96:99]
    v_mfma_f32_16x16x32_bf16 v[100:103], v[232:235], v[36:39], v[100:103]
    v_mfma_f32_16x16x32_bf16 v[104:107], v[232:235], v[40:43], v[104:107]
    v_mfma_f32_16x16x32_bf16 v[108:111], v[232:235], v[44:47], v[108:111]
    s_waitcnt lgkmcnt(2)
    v_mfma_f32_16x16x32_bf16 v[112:115], v[236:239], v[32:35], v[112:115]
    v_mfma_f32_16x16x32_bf16 v[116:119], v[236:239], v[36:39], v[116:119]
    v_mfma_f32_16x16x32_bf16 v[120:123], v[236:239], v[40:43], v[120:123]
    v_mfma_f32_16x16x32_bf16 v[124:127], v[236:239], v[44:47], v[124:127]
    s_waitcnt lgkmcnt(0)
    v_mfma_f32_16x16x32_bf16 v[128:131], v[240:243], v[32:35], v[128:131]
    v_mfma_f32_16x16x32_bf16 v[132:135], v[240:243], v[36:39], v[132:135]
    v_mfma_f32_16x16x32_bf16 v[136:139], v[240:243], v[40:43], v[136:139]
    v_mfma_f32_16x16x32_bf16 v[140:143], v[240:243], v[44:47], v[140:143]
    s_add_u32 m0, s34, 0
    s_nop 0
    buffer_load_dwordx4 v4, s[16:19], s40 offen lds
    s_add_u32 m0, s34, 1024
    s_nop 0
    buffer_load_dwordx4 v5, s[16:19], s40 offen lds
    s_add_u32 m0, s34, 2048
    s_nop 0
    buffer_load_dwordx4 v6, s[16:19], s40 offen lds
    s_add_u32 m0, s34, 3072
    s_nop 0
    buffer_load_dwordx4 v7, s[16:19], s40 offen lds
    s_add_u32 m0, s34, 4096
    s_nop 0
    buffer_load_dwordx4 v8, s[16:19], s40 offen lds
    s_add_u32 s42, s41, 0
    buffer_load_dwordx4 v[32:35], v9, s[24:27], s42 offen
    s_add_u32 s42, s41, 20480
    buffer_load_dwordx4 v[36:39], v9, s[24:27], s42 offen
    s_add_u32 s42, s41, 40960
    buffer_load_dwordx4 v[40:43], v9, s[24:27], s42 offen
    s_add_u32 s42, s41, 61440
    buffer_load_dwordx4 v[44:47], v9, s[24:27], s42 offen
    s_add_u32 s40, s40, 163840
    s_add_u32 s41, s41, 256
    s_waitcnt vmcnt(18)
    ds_read_b64_tr_b16 v[224:225], v11 offset:10240
    ds_read_b64_tr_b16 v[226:227], v11 offset:10880
    ds_read_b64_tr_b16 v[228:229], v11 offset:10272
    ds_read_b64_tr_b16 v[230:231], v11 offset:10912
    ds_read_b64_tr_b16 v[232:233], v11 offset:10304
    ds_read_b64_tr_b16 v[234:235], v11 offset:10944
    ds_read_b64_tr_b16 v[236:237], v11 offset:10336
    ds_read_b64_tr_b16 v[238:239], v11 offset:10976
    ds_read_b64_tr_b16 v[240:241], v11 offset:10368
    ds_read_b64_tr_b16 v[242:243], v11 offset:11008
    s_waitcnt lgkmcnt(8)
    v_mfma_f32_16x16x32_bf16 v[64:67], v[224:227], v[48:51], v[64:67]
    v_mfma_f32_16x16x32_bf16 v[68:71], v[224:227], v[52:55], v[68:71]
    v_mfma_f32_16x16x32_bf16 v[72:75], v[224:227], v[56:59], v[72:75]
    v_mfma_f32_16x16x32_bf16 v[76:79], v[224:227], v[60:63], v[76:79]
    s_waitcnt lgkmcnt(6)
    v_mfma_f32_16x16x32_bf16 v[80:83], v[228:231], v[48:51], v[80:83]
    v_mfma_f32_16x16x32_bf16 v[84:87], v[228:231], v[52:55], v[84:87]
    v_mfma_f32_16x16x32_bf16 v[88:91], v[228:231], v[56:59], v[88:91]
    v_mfma_f32_16x16x32_bf16 v[92:95], v[228:231], v[60:63], v[92:95]
    s_waitcnt lgkmcnt(4)
    v_mfma_f32_16x16x32_bf16 v[96:99], v[232:235], v[48:51], v[96:99]
    v_mfma_f32_16x16x32_bf16 v[100:103], v[232:235], v[52:55], v[100:103]
    v_mfma_f32_16x16x32_bf16 v[104:107], v[232:235], v[56:59], v[104:107]
    v_mfma_f32_16x16x32_bf16 v[108:111], v[232:235], v[60:63], v[108:111]
    s_waitcnt lgkmcnt(2)
    v_mfma_f32_16x16x32_bf16 v[112:115], v[236:239], v[48:51], v[112:115]
    v_mfma_f32_16x16x32_bf16 v[116:119], v[236:239], v[52:55], v[116:119]
    v_mfma_f32_16x16x32_bf16 v[120:123], v[236:239], v[56:59], v[120:123]
    v_mfma_f32_16x16x32_bf16 v[124:127], v[236:239], v[60:63], v[124:127]
    s_waitcnt lgkmcnt(0)
    v_mfma_f32_16x16x32_bf16 v[128:131], v[240:243], v[48:51], v[128:131]
    v_mfma_f32_16x16x32_bf16 v[132:135], v[240:243], v[52:55], v[132:135]
    v_mfma_f32_16x16x32_bf16 v[136:139], v[240:243], v[56:59], v[136:139]
    v_mfma_f32_16x16x32_bf16 v[140:143], v[240:243], v[60:63], v[140:143]
    s_mul_i32 s40, s30, 40960
    s_lshl_b32 s41, s30, 6
    s_add_u32 m0, s34, 5120
    s_nop 0
    buffer_load_dwordx4 v4, s[20:23], s40 offen lds
    s_add_u32 m0, s34, 6144
    s_nop 0
    buffer_load_dwordx4 v5, s[20:23], s40 offen lds
    s_add_u32 m0, s34, 7168
    s_nop 0
    buffer_load_dwordx4 v6, s[20:23], s40 offen lds
    s_add_u32 m0, s34, 8192
    s_nop 0
    buffer_load_dwordx4 v7, s[20:23], s40 offen lds
    s_add_u32 m0, s34, 9216
    s_nop 0
    buffer_load_dwordx4 v8, s[20:23], s40 offen lds
    s_add_u32 s42, s41, 0
    buffer_load_dwordx4 v[48:51], v10, s[24:27], s42 offen
    s_add_u32 s42, s41, 55296
    buffer_load_dwordx4 v[52:55], v10, s[24:27], s42 offen
    s_add_u32 s42, s41, 110592
    buffer_load_dwordx4 v[56:59], v10, s[24:27], s42 offen
    s_add_u32 s42, s41, 165888
    buffer_load_dwordx4 v[60:63], v10, s[24:27], s42 offen
    s_add_u32 s40, s40, 163840
    s_add_u32 s41, s41, 256
    s_waitcnt vmcnt(18)
    ds_read_b64_tr_b16 v[224:225], v11 offset:15360
    ds_read_b64_tr_b16 v[226:227], v11 offset:16000
    ds_read_b64_tr_b16 v[228:229], v11 offset:15392
    ds_read_b64_tr_b16 v[230:231], v11 offset:16032
    ds_read_b64_tr_b16 v[232:233], v11 offset:15424
    ds_read_b64_tr_b16 v[234:235], v11 offset:16064
    ds_read_b64_tr_b16 v[236:237], v11 offset:15456
    ds_read_b64_tr_b16 v[238:239], v11 offset:16096
    ds_read_b64_tr_b16 v[240:241], v11 offset:15488
    ds_read_b64_tr_b16 v[242:243], v11 offset:16128
    s_waitcnt lgkmcnt(8)
    v_mfma_f32_16x16x32_bf16 v[64:67], v[224:227], v[16:19], v[64:67]
    v_mfma_f32_16x16x32_bf16 v[68:71], v[224:227], v[20:23], v[68:71]
    v_mfma_f32_16x16x32_bf16 v[72:75], v[224:227], v[24:27], v[72:75]
    v_mfma_f32_16x16x32_bf16 v[76:79], v[224:227], v[28:31], v[76:79]
    s_waitcnt lgkmcnt(6)
    v_mfma_f32_16x16x32_bf16 v[80:83], v[228:231], v[16:19], v[80:83]
    v_mfma_f32_16x16x32_bf16 v[84:87], v[228:231], v[20:23], v[84:87]
    v_mfma_f32_16x16x32_bf16 v[88:91], v[228:231], v[24:27], v[88:91]
    v_mfma_f32_16x16x32_bf16 v[92:95], v[228:231], v[28:31], v[92:95]
    s_waitcnt lgkmcnt(4)
    v_mfma_f32_16x16x32_bf16 v[96:99], v[232:235], v[16:19], v[96:99]
    v_mfma_f32_16x16x32_bf16 v[100:103], v[232:235], v[20:23], v[100:103]
    v_mfma_f32_16x16x32_bf16 v[104:107], v[232:235], v[24:27], v[104:107]
    v_mfma_f32_16x16x32_bf16 v[108:111], v[232:235], v[28:31], v[108:111]
    s_waitcnt lgkmcnt(2)
    v_mfma_f32_16x16x32_bf16 v[112:115], v[236:239], v[16:19], v[112:115]
    v_mfma_f32_16x16x32_bf16 v[116:119], v[236:239], v[20:23], v[116:119]
    v_mfma_f32_16x16x32_bf16 v[120:123], v[236:239], v[24:27], v[120:123]
    v_mfma_f32_16x16x32_bf16 v[124:127], v[236:239], v[28:31], v[124:127]
    s_waitcnt lgkmcnt(0)
    v_mfma_f32_16x16x32_bf16 v[128:131], v[240:243], v[16:19], v[128:131]
    v_mfma_f32_16x16x32_bf16 v[132:135], v[240:243], v[20:23], v[132:135]
    v_mfma_f32_16x16x32_bf16 v[136:139], v[240:243], v[24:27], v[136:139]
    v_mfma_f32_16x16x32_bf16 v[140:143], v[240:243], v[28:31], v[140:143]
    s_add_u32 m0, s34, 10240
    s_nop 0
    buffer_load_dwordx4 v4, s[20:23], s40 offen lds
    s_add_u32 m0, s34, 11264
    s_nop 0
    buffer_load_dwordx4 v5, s[20:23], s40 offen lds
    s_add_u32 m0, s34, 12288
    s_nop 0
    buffer_load_dwordx4 v6, s[20:23], s40 offen lds
    s_add_u32 m0, s34, 13312
    s_nop 0
    buffer_load_dwordx4 v7, s[20:23], s40 offen lds
    s_add_u32 m0, s34, 14336
    s_nop 0
    buffer_load_dwordx4 v8, s[20:23], s40 offen lds
    s_add_u32 s42, s41, 0
    buffer_load_dwordx4 v[16:19], v10, s[24:27], s42 offen
    s_add_u32 s42, s41, 55296
    buffer_load_dwordx4 v[20:23], v10, s[24:27], s42 offen
    s_add_u32 s42, s41, 110592
    buffer_load_dwordx4 v[24:27], v10, s[24:27], s42 offen
    s_add_u32 s42, s41, 165888
    buffer_load_dwordx4 v[28:31], v10, s[24:27], s42 offen
    s_add_u32 s40, s40, 163840
    s_add_u32 s41, s41, 256
    s_waitcnt vmcnt(18)
    ds_read_b64_tr_b16 v[224:225], v11 offset:0
    ds_read_b64_tr_b16 v[226:227], v11 offset:640
    ds_read_b64_tr_b16 v[228:229], v11 offset:32
    ds_read_b64_tr_b16 v[230:231], v11 offset:672
    ds_read_b64_tr_b16 v[232:233], v11 offset:64
    ds_read_b64_tr_b16 v[234:235], v11 offset:704
    ds_read_b64_tr_b16 v[236:237], v11 offset:96
    ds_read_b64_tr_b16 v[238:239], v11 offset:736
    ds_read_b64_tr_b16 v[240:241], v11 offset:128
    ds_read_b64_tr_b16 v[242:243], v11 offset:768
    s_waitcnt lgkmcnt(8)
    v_mfma_f32_16x16x32_bf16 v[64:67], v[224:227], v[32:35], v[64:67]
    v_mfma_f32_16x16x32_bf16 v[68:71], v[224:227], v[36:39], v[68:71]
    v_mfma_f32_16x16x32_bf16 v[72:75], v[224:227], v[40:43], v[72:75]
    v_mfma_f32_16x16x32_bf16 v[76:79], v[224:227], v[44:47], v[76:79]
    s_waitcnt lgkmcnt(6)
    v_mfma_f32_16x16x32_bf16 v[80:83], v[228:231], v[32:35], v[80:83]
    v_mfma_f32_16x16x32_bf16 v[84:87], v[228:231], v[36:39], v[84:87]
    v_mfma_f32_16x16x32_bf16 v[88:91], v[228:231], v[40:43], v[88:91]
    v_mfma_f32_16x16x32_bf16 v[92:95], v[228:231], v[44:47], v[92:95]
    s_waitcnt lgkmcnt(4)
    v_mfma_f32_16x16x32_bf16 v[96:99], v[232:235], v[32:35], v[96:99]
    v_mfma_f32_16x16x32_bf16 v[100:103], v[232:235], v[36:39], v[100:103]
    v_mfma_f32_16x16x32_bf16 v[104:107], v[232:235], v[40:43], v[104:107]
    v_mfma_f32_16x16x32_bf16 v[108:111], v[232:235], v[44:47], v[108:111]
    s_waitcnt lgkmcnt(2)
    v_mfma_f32_16x16x32_bf16 v[112:115], v[236:239], v[32:35], v[112:115]
    v_mfma_f32_16x16x32_bf16 v[116:119], v[236:239], v[36:39], v[116:119]
    v_mfma_f32_16x16x32_bf16 v[120:123], v[236:239], v[40:43], v[120:123]
    v_mfma_f32_16x16x32_bf16 v[124:127], v[236:239], v[44:47], v[124:127]
    s_waitcnt lgkmcnt(0)
    v_mfma_f32_16x16x32_bf16 v[128:131], v[240:243], v[32:35], v[128:131]
    v_mfma_f32_16x16x32_bf16 v[132:135], v[240:243], v[36:39], v[132:135]
    v_mfma_f32_16x16x32_bf16 v[136:139], v[240:243], v[40:43], v[136:139]
    v_mfma_f32_16x16x32_bf16 v[140:143], v[240:243], v[44:47], v[140:143]
    s_add_u32 m0, s34, 15360
    s_nop 0
    buffer_load_dwordx4 v4, s[20:23], s40 offen lds
    s_add_u32 m0, s34, 16384
    s_nop 0
    buffer_load_dwordx4 v5, s[20:23], s40 offen lds
    s_add_u32 m0, s34, 17408
    s_nop 0
    buffer_load_dwordx4 v6, s[20:23], s40 offen lds
    s_add_u32 m0, s34, 18432
    s_nop 0
    buffer_load_dwordx4 v7, s[20:23], s40 offen lds
    s_add_u32 m0, s34, 19456
    s_nop 0
    buffer_load_dwordx4 v8, s[20:23], s40 offen lds
    s_add_u32 s42, s41, 0
    buffer_load_dwordx4 v[32:35], v10, s[24:27], s42 offen
    s_add_u32 s42, s41, 55296
    buffer_load_dwordx4 v[36:39], v10, s[24:27], s42 offen
    s_add_u32 s42, s41, 110592
    buffer_load_dwordx4 v[40:43], v10, s[24:27], s42 offen
    s_add_u32 s42, s41, 165888
    buffer_load_dwordx4 v[44:47], v10, s[24:27], s42 offen
    s_add_u32 s40, s40, 163840
    s_add_u32 s41, s41, 256
    s_waitcnt vmcnt(18)
    ds_read_b64_tr_b16 v[224:225], v11 offset:5120
    ds_read_b64_tr_b16 v[226:227], v11 offset:5760
    ds_read_b64_tr_b16 v[228:229], v11 offset:5152
    ds_read_b64_tr_b16 v[230:231], v11 offset:5792
    ds_read_b64_tr_b16 v[232:233], v11 offset:5184
    ds_read_b64_tr_b16 v[234:235], v11 offset:5824
    ds_read_b64_tr_b16 v[236:237], v11 offset:5216
    ds_read_b64_tr_b16 v[238:239], v11 offset:5856
    ds_read_b64_tr_b16 v[240:241], v11 offset:5248
    ds_read_b64_tr_b16 v[242:243], v11 offset:5888
    s_waitcnt lgkmcnt(8)
    v_mfma_f32_16x16x32_bf16 v[144:147], v[224:227], v[48:51], 0
    v_mfma_f32_16x16x32_bf16 v[148:151], v[224:227], v[52:55], 0
    v_mfma_f32_16x16x32_bf16 v[152:155], v[224:227], v[56:59], 0
    v_mfma_f32_16x16x32_bf16 v[156:159], v[224:227], v[60:63], 0
    s_waitcnt lgkmcnt(6)
    v_mfma_f32_16x16x32_bf16 v[160:163], v[228:231], v[48:51], 0
    v_mfma_f32_16x16x32_bf16 v[164:167], v[228:231], v[52:55], 0
    v_mfma_f32_16x16x32_bf16 v[168:171], v[228:231], v[56:59], 0
    v_mfma_f32_16x16x32_bf16 v[172:175], v[228:231], v[60:63], 0
    s_waitcnt lgkmcnt(4)
    v_mfma_f32_16x16x32_bf16 v[176:179], v[232:235], v[48:51], 0
    v_mfma_f32_16x16x32_bf16 v[180:183], v[232:235], v[52:55], 0
    v_mfma_f32_16x16x32_bf16 v[184:187], v[232:235], v[56:59], 0
    v_mfma_f32_16x16x32_bf16 v[188:191], v[232:235], v[60:63], 0
    s_waitcnt lgkmcnt(2)
    v_mfma_f32_16x16x32_bf16 v[192:195], v[236:239], v[48:51], 0
    v_mfma_f32_16x16x32_bf16 v[196:199], v[236:239], v[52:55], 0
    v_mfma_f32_16x16x32_bf16 v[200:203], v[236:239], v[56:59], 0
    v_mfma_f32_16x16x32_bf16 v[204:207], v[236:239], v[60:63], 0
    s_waitcnt lgkmcnt(0)
    v_mfma_f32_16x16x32_bf16 v[208:211], v[240:243], v[48:51], 0
    v_mfma_f32_16x16x32_bf16 v[212:215], v[240:243], v[52:55], 0
    v_mfma_f32_16x16x32_bf16 v[216:219], v[240:243], v[56:59], 0
    v_mfma_f32_16x16x32_bf16 v[220:223], v[240:243], v[60:63], 0
    s_add_u32 m0, s34, 0
    s_nop 0
    buffer_load_dwordx4 v4, s[20:23], s40 offen lds
    s_add_u32 m0, s34, 1024
    s_nop 0
    buffer_load_dwordx4 v5, s[20:23], s40 offen lds
    s_add_u32 m0, s34, 2048
    s_nop 0
    buffer_load_dwordx4 v6, s[20:23], s40 offen lds
    s_add_u32 m0, s34, 3072
    s_nop 0
    buffer_load_dwordx4 v7, s[20:23], s40 offen lds
    s_add_u32 m0, s34, 4096
    s_nop 0
    buffer_load_dwordx4 v8, s[20:23], s40 offen lds
    s_add_u32 s42, s41, 0
    buffer_load_dwordx4 v[48:51], v10, s[24:27], s42 offen
    s_add_u32 s42, s41, 55296
    buffer_load_dwordx4 v[52:55], v10, s[24:27], s42 offen
    s_add_u32 s42, s41, 110592
    buffer_load_dwordx4 v[56:59], v10, s[24:27], s42 offen
    s_add_u32 s42, s41, 165888
    buffer_load_dwordx4 v[60:63], v10, s[24:27], s42 offen
    s_add_u32 s40, s40, 163840
    s_add_u32 s41, s41, 256
    s_waitcnt vmcnt(18)
    ds_read_b64_tr_b16 v[224:225], v11 offset:10240
    ds_read_b64_tr_b16 v[226:227], v11 offset:10880
    ds_read_b64_tr_b16 v[228:229], v11 offset:10272
    ds_read_b64_tr_b16 v[230:231], v11 offset:10912
    ds_read_b64_tr_b16 v[232:233], v11 offset:10304
    ds_read_b64_tr_b16 v[234:235], v11 offset:10944
    ds_read_b64_tr_b16 v[236:237], v11 offset:10336
    ds_read_b64_tr_b16 v[238:239], v11 offset:10976
    ds_read_b64_tr_b16 v[240:241], v11 offset:10368
    ds_read_b64_tr_b16 v[242:243], v11 offset:11008
    s_waitcnt lgkmcnt(8)
    v_mfma_f32_16x16x32_bf16 v[144:147], v[224:227], v[16:19], v[144:147]
    v_mfma_f32_16x16x32_bf16 v[148:151], v[224:227], v[20:23], v[148:151]
    v_mfma_f32_16x16x32_bf16 v[152:155], v[224:227], v[24:27], v[152:155]
    v_mfma_f32_16x16x32_bf16 v[156:159], v[224:227], v[28:31], v[156:159]
    s_waitcnt lgkmcnt(6)
    v_mfma_f32_16x16x32_bf16 v[160:163], v[228:231], v[16:19], v[160:163]
    v_mfma_f32_16x16x32_bf16 v[164:167], v[228:231], v[20:23], v[164:167]
    v_mfma_f32_16x16x32_bf16 v[168:171], v[228:231], v[24:27], v[168:171]
    v_mfma_f32_16x16x32_bf16 v[172:175], v[228:231], v[28:31], v[172:175]
    s_waitcnt lgkmcnt(4)
    v_mfma_f32_16x16x32_bf16 v[176:179], v[232:235], v[16:19], v[176:179]
    v_mfma_f32_16x16x32_bf16 v[180:183], v[232:235], v[20:23], v[180:183]
    v_mfma_f32_16x16x32_bf16 v[184:187], v[232:235], v[24:27], v[184:187]
    v_mfma_f32_16x16x32_bf16 v[188:191], v[232:235], v[28:31], v[188:191]
    s_waitcnt lgkmcnt(2)
    v_mfma_f32_16x16x32_bf16 v[192:195], v[236:239], v[16:19], v[192:195]
    v_mfma_f32_16x16x32_bf16 v[196:199], v[236:239], v[20:23], v[196:199]
    v_mfma_f32_16x16x32_bf16 v[200:203], v[236:239], v[24:27], v[200:203]
    v_mfma_f32_16x16x32_bf16 v[204:207], v[236:239], v[28:31], v[204:207]
    s_waitcnt lgkmcnt(0)
    v_mfma_f32_16x16x32_bf16 v[208:211], v[240:243], v[16:19], v[208:211]
    v_mfma_f32_16x16x32_bf16 v[212:215], v[240:243], v[20:23], v[212:215]
    v_mfma_f32_16x16x32_bf16 v[216:219], v[240:243], v[24:27], v[216:219]
    v_mfma_f32_16x16x32_bf16 v[220:223], v[240:243], v[28:31], v[220:223]
    s_add_u32 m0, s34, 5120
    s_nop 0
    buffer_load_dwordx4 v4, s[20:23], s40 offen lds
    s_add_u32 m0, s34, 6144
    s_nop 0
    buffer_load_dwordx4 v5, s[20:23], s40 offen lds
    s_add_u32 m0, s34, 7168
    s_nop 0
    buffer_load_dwordx4 v6, s[20:23], s40 offen lds
    s_add_u32 m0, s34, 8192
    s_nop 0
    buffer_load_dwordx4 v7, s[20:23], s40 offen lds
    s_add_u32 m0, s34, 9216
    s_nop 0
    buffer_load_dwordx4 v8, s[20:23], s40 offen lds
    s_add_u32 s42, s41, 0
    buffer_load_dwordx4 v[16:19], v10, s[24:27], s42 offen
    s_add_u32 s42, s41, 55296
    buffer_load_dwordx4 v[20:23], v10, s[24:27], s42 offen
    s_add_u32 s42, s41, 110592
    buffer_load_dwordx4 v[24:27], v10, s[24:27], s42 offen
    s_add_u32 s42, s41, 165888
    buffer_load_dwordx4 v[28:31], v10, s[24:27], s42 offen
    s_add_u32 s40, s40, 163840
    s_add_u32 s41, s41, 256
    s_waitcnt vmcnt(18)
    ds_read_b64_tr_b16 v[224:225], v11 offset:15360
    ds_read_b64_tr_b16 v[226:227], v11 offset:16000
    ds_read_b64_tr_b16 v[228:229], v11 offset:15392
    ds_read_b64_tr_b16 v[230:231], v11 offset:16032
    ds_read_b64_tr_b16 v[232:233], v11 offset:15424
    ds_read_b64_tr_b16 v[234:235], v11 offset:16064
    ds_read_b64_tr_b16 v[236:237], v11 offset:15456
    ds_read_b64_tr_b16 v[238:239], v11 offset:16096
    ds_read_b64_tr_b16 v[240:241], v11 offset:15488
    ds_read_b64_tr_b16 v[242:243], v11 offset:16128
    s_waitcnt lgkmcnt(8)
    v_mfma_f32_16x16x32_bf16 v[144:147], v[224:227], v[32:35], v[144:147]
    v_mfma_f32_16x16x32_bf16 v[148:151], v[224:227], v[36:39], v[148:151]
    v_mfma_f32_16x16x32_bf16 v[152:155], v[224:227], v[40:43], v[152:155]
    v_mfma_f32_16x16x32_bf16 v[156:159], v[224:227], v[44:47], v[156:159]
    s_waitcnt lgkmcnt(6)
    v_mfma_f32_16x16x32_bf16 v[160:163], v[228:231], v[32:35], v[160:163]
    v_mfma_f32_16x16x32_bf16 v[164:167], v[228:231], v[36:39], v[164:167]
    v_mfma_f32_16x16x32_bf16 v[168:171], v[228:231], v[40:43], v[168:171]
    v_mfma_f32_16x16x32_bf16 v[172:175], v[228:231], v[44:47], v[172:175]
    s_waitcnt lgkmcnt(4)
    v_mfma_f32_16x16x32_bf16 v[176:179], v[232:235], v[32:35], v[176:179]
    v_mfma_f32_16x16x32_bf16 v[180:183], v[232:235], v[36:39], v[180:183]
    v_mfma_f32_16x16x32_bf16 v[184:187], v[232:235], v[40:43], v[184:187]
    v_mfma_f32_16x16x32_bf16 v[188:191], v[232:235], v[44:47], v[188:191]
    s_waitcnt lgkmcnt(2)
    v_mfma_f32_16x16x32_bf16 v[192:195], v[236:239], v[32:35], v[192:195]
    v_mfma_f32_16x16x32_bf16 v[196:199], v[236:239], v[36:39], v[196:199]
    v_mfma_f32_16x16x32_bf16 v[200:203], v[236:239], v[40:43], v[200:203]
    v_mfma_f32_16x16x32_bf16 v[204:207], v[236:239], v[44:47], v[204:207]
    s_waitcnt lgkmcnt(0)
    v_mfma_f32_16x16x32_bf16 v[208:211], v[240:243], v[32:35], v[208:211]
    v_mfma_f32_16x16x32_bf16 v[212:215], v[240:243], v[36:39], v[212:215]
    v_mfma_f32_16x16x32_bf16 v[216:219], v[240:243], v[40:43], v[216:219]
    v_mfma_f32_16x16x32_bf16 v[220:223], v[240:243], v[44:47], v[220:223]
    s_add_u32 m0, s34, 10240
    s_nop 0
    buffer_load_dwordx4 v4, s[20:23], s40 offen lds
    s_add_u32 m0, s34, 11264
    s_nop 0
    buffer_load_dwordx4 v5, s[20:23], s40 offen lds
    s_add_u32 m0, s34, 12288
    s_nop 0
    buffer_load_dwordx4 v6, s[20:23], s40 offen lds
    s_add_u32 m0, s34, 13312
    s_nop 0
    buffer_load_dwordx4 v7, s[20:23], s40 offen lds
    s_add_u32 m0, s34, 14336
    s_nop 0
    buffer_load_dwordx4 v8, s[20:23], s40 offen lds
    s_add_u32 s42, s41, 0
    buffer_load_dwordx4 v[32:35], v10, s[24:27], s42 offen
    s_add_u32 s42, s41, 55296
    buffer_load_dwordx4 v[36:39], v10, s[24:27], s42 offen
    s_add_u32 s42, s41, 110592
    buffer_load_dwordx4 v[40:43], v10, s[24:27], s42 offen
    s_add_u32 s42, s41, 165888
    buffer_load_dwordx4 v[44:47], v10, s[24:27], s42 offen
    s_add_u32 s40, s40, 163840
    s_add_u32 s41, s41, 256
    s_waitcnt vmcnt(18)
    ds_read_b64_tr_b16 v[224:225], v11 offset:0
    ds_read_b64_tr_b16 v[226:227], v11 offset:640
    ds_read_b64_tr_b16 v[228:229], v11 offset:32
    ds_read_b64_tr_b16 v[230:231], v11 offset:672
    ds_read_b64_tr_b16 v[232:233], v11 offset:64
    ds_read_b64_tr_b16 v[234:235], v11 offset:704
    ds_read_b64_tr_b16 v[236:237], v11 offset:96
    ds_read_b64_tr_b16 v[238:239], v11 offset:736
    ds_read_b64_tr_b16 v[240:241], v11 offset:128
    ds_read_b64_tr_b16 v[242:243], v11 offset:768
    s_waitcnt lgkmcnt(8)
    v_mfma_f32_16x16x32_bf16 v[144:147], v[224:227], v[48:51], v[144:147]
    v_mfma_f32_16x16x32_bf16 v[148:151], v[224:227], v[52:55], v[148:151]
    v_mfma_f32_16x16x32_bf16 v[152:155], v[224:227], v[56:59], v[152:155]
    v_mfma_f32_16x16x32_bf16 v[156:159], v[224:227], v[60:63], v[156:159]
    s_waitcnt lgkmcnt(6)
    v_mfma_f32_16x16x32_bf16 v[160:163], v[228:231], v[48:51], v[160:163]
    v_mfma_f32_16x16x32_bf16 v[164:167], v[228:231], v[52:55], v[164:167]
    v_mfma_f32_16x16x32_bf16 v[168:171], v[228:231], v[56:59], v[168:171]
    v_mfma_f32_16x16x32_bf16 v[172:175], v[228:231], v[60:63], v[172:175]
    s_waitcnt lgkmcnt(4)
    v_mfma_f32_16x16x32_bf16 v[176:179], v[232:235], v[48:51], v[176:179]
    v_mfma_f32_16x16x32_bf16 v[180:183], v[232:235], v[52:55], v[180:183]
    v_mfma_f32_16x16x32_bf16 v[184:187], v[232:235], v[56:59], v[184:187]
    v_mfma_f32_16x16x32_bf16 v[188:191], v[232:235], v[60:63], v[188:191]
    s_waitcnt lgkmcnt(2)
    v_mfma_f32_16x16x32_bf16 v[192:195], v[236:239], v[48:51], v[192:195]
    v_mfma_f32_16x16x32_bf16 v[196:199], v[236:239], v[52:55], v[196:199]
    v_mfma_f32_16x16x32_bf16 v[200:203], v[236:239], v[56:59], v[200:203]
    v_mfma_f32_16x16x32_bf16 v[204:207], v[236:239], v[60:63], v[204:207]
    s_waitcnt lgkmcnt(0)
    v_mfma_f32_16x16x32_bf16 v[208:211], v[240:243], v[48:51], v[208:211]
    v_mfma_f32_16x16x32_bf16 v[212:215], v[240:243], v[52:55], v[212:215]
    v_mfma_f32_16x16x32_bf16 v[216:219], v[240:243], v[56:59], v[216:219]
    v_mfma_f32_16x16x32_bf16 v[220:223], v[240:243], v[60:63], v[220:223]
    s_add_u32 m0, s34, 15360
    s_nop 0
    buffer_load_dwordx4 v4, s[20:23], s40 offen lds
    s_add_u32 m0, s34, 16384
    s_nop 0
    buffer_load_dwordx4 v5, s[20:23], s40 offen lds
    s_add_u32 m0, s34, 17408
    s_nop 0
    buffer_load_dwordx4 v6, s[20:23], s40 offen lds
    s_add_u32 m0, s34, 18432
    s_nop 0
    buffer_load_dwordx4 v7, s[20:23], s40 offen lds
    s_add_u32 m0, s34, 19456
    s_nop 0
    buffer_load_dwordx4 v8, s[20:23], s40 offen lds
    s_add_u32 s42, s41, 0
    buffer_load_dwordx4 v[48:51], v10, s[24:27], s42 offen
    s_add_u32 s42, s41, 55296
    buffer_load_dwordx4 v[52:55], v10, s[24:27], s42 offen
    s_add_u32 s42, s41, 110592
    buffer_load_dwordx4 v[56:59], v10, s[24:27], s42 offen
    s_add_u32 s42, s41, 165888
    buffer_load_dwordx4 v[60:63], v10, s[24:27], s42 offen
    s_add_u32 s40, s40, 163840
    s_add_u32 s41, s41, 256
    s_waitcnt vmcnt(18)
    ds_read_b64_tr_b16 v[224:225], v11 offset:5120
    ds_read_b64_tr_b16 v[226:227], v11 offset:5760
    ds_read_b64_tr_b16 v[228:229], v11 offset:5152
    ds_read_b64_tr_b16 v[230:231], v11 offset:5792
    ds_read_b64_tr_b16 v[232:233], v11 offset:5184
    ds_read_b64_tr_b16 v[234:235], v11 offset:5824
    ds_read_b64_tr_b16 v[236:237], v11 offset:5216
    ds_read_b64_tr_b16 v[238:239], v11 offset:5856
    ds_read_b64_tr_b16 v[240:241], v11 offset:5248
    ds_read_b64_tr_b16 v[242:243], v11 offset:5888
    s_waitcnt lgkmcnt(8)
    v_mfma_f32_16x16x32_bf16 v[144:147], v[224:227], v[16:19], v[144:147]
    v_mfma_f32_16x16x32_bf16 v[148:151], v[224:227], v[20:23], v[148:151]
    v_mfma_f32_16x16x32_bf16 v[152:155], v[224:227], v[24:27], v[152:155]
    v_mfma_f32_16x16x32_bf16 v[156:159], v[224:227], v[28:31], v[156:159]
    s_waitcnt lgkmcnt(6)
    v_mfma_f32_16x16x32_bf16 v[160:163], v[228:231], v[16:19], v[160:163]
    v_mfma_f32_16x16x32_bf16 v[164:167], v[228:231], v[20:23], v[164:167]
    v_mfma_f32_16x16x32_bf16 v[168:171], v[228:231], v[24:27], v[168:171]
    v_mfma_f32_16x16x32_bf16 v[172:175], v[228:231], v[28:31], v[172:175]
    s_waitcnt lgkmcnt(4)
    v_mfma_f32_16x16x32_bf16 v[176:179], v[232:235], v[16:19], v[176:179]
    v_mfma_f32_16x16x32_bf16 v[180:183], v[232:235], v[20:23], v[180:183]
    v_mfma_f32_16x16x32_bf16 v[184:187], v[232:235], v[24:27], v[184:187]
    v_mfma_f32_16x16x32_bf16 v[188:191], v[232:235], v[28:31], v[188:191]
    s_waitcnt lgkmcnt(2)
    v_mfma_f32_16x16x32_bf16 v[192:195], v[236:239], v[16:19], v[192:195]
    v_mfma_f32_16x16x32_bf16 v[196:199], v[236:239], v[20:23], v[196:199]
    v_mfma_f32_16x16x32_bf16 v[200:203], v[236:239], v[24:27], v[200:203]
    v_mfma_f32_16x16x32_bf16 v[204:207], v[236:239], v[28:31], v[204:207]
    s_waitcnt lgkmcnt(0)
    v_mfma_f32_16x16x32_bf16 v[208:211], v[240:243], v[16:19], v[208:211]
    v_mfma_f32_16x16x32_bf16 v[212:215], v[240:243], v[20:23], v[212:215]
    v_mfma_f32_16x16x32_bf16 v[216:219], v[240:243], v[24:27], v[216:219]
    v_mfma_f32_16x16x32_bf16 v[220:223], v[240:243], v[28:31], v[220:223]
    s_add_u32 m0, s34, 0
    s_nop 0
    buffer_load_dwordx4 v4, s[20:23], s40 offen lds
    s_add_u32 m0, s34, 1024
    s_nop 0
    buffer_load_dwordx4 v5, s[20:23], s40 offen lds
    s_add_u32 m0, s34, 2048
    s_nop 0
    buffer_load_dwordx4 v6, s[20:23], s40 offen lds
    s_add_u32 m0, s34, 3072
    s_nop 0
    buffer_load_dwordx4 v7, s[20:23], s40 offen lds
    s_add_u32 m0, s34, 4096
    s_nop 0
    buffer_load_dwordx4 v8, s[20:23], s40 offen lds
    s_add_u32 s42, s41, 0
    buffer_load_dwordx4 v[16:19], v10, s[24:27], s42 offen
    s_add_u32 s42, s41, 55296
    buffer_load_dwordx4 v[20:23], v10, s[24:27], s42 offen
    s_add_u32 s42, s41, 110592
    buffer_load_dwordx4 v[24:27], v10, s[24:27], s42 offen
    s_add_u32 s42, s41, 165888
    buffer_load_dwordx4 v[28:31], v10, s[24:27], s42 offen
    s_add_u32 s40, s40, 163840
    s_add_u32 s41, s41, 256
    s_waitcnt vmcnt(18)
    ds_read_b64_tr_b16 v[224:225], v11 offset:10240
    ds_read_b64_tr_b16 v[226:227], v11 offset:10880
    ds_read_b64_tr_b16 v[228:229], v11 offset:10272
    ds_read_b64_tr_b16 v[230:231], v11 offset:10912
    ds_read_b64_tr_b16 v[232:233], v11 offset:10304
    ds_read_b64_tr_b16 v[234:235], v11 offset:10944
    ds_read_b64_tr_b16 v[236:237], v11 offset:10336
    ds_read_b64_tr_b16 v[238:239], v11 offset:10976
    ds_read_b64_tr_b16 v[240:241], v11 offset:10368
    ds_read_b64_tr_b16 v[242:243], v11 offset:11008
    s_waitcnt lgkmcnt(8)
    v_mfma_f32_16x16x32_bf16 v[144:147], v[224:227], v[32:35], v[144:147]
    v_mfma_f32_16x16x32_bf16 v[148:151], v[224:227], v[36:39], v[148:151]
    v_mfma_f32_16x16x32_bf16 v[152:155], v[224:227], v[40:43], v[152:155]
    v_mfma_f32_16x16x32_bf16 v[156:159], v[224:227], v[44:47], v[156:159]
    s_waitcnt lgkmcnt(6)
    v_mfma_f32_16x16x32_bf16 v[160:163], v[228:231], v[32:35], v[160:163]
    v_mfma_f32_16x16x32_bf16 v[164:167], v[228:231], v[36:39], v[164:167]
    v_mfma_f32_16x16x32_bf16 v[168:171], v[228:231], v[40:43], v[168:171]
    v_mfma_f32_16x16x32_bf16 v[172:175], v[228:231], v[44:47], v[172:175]
    s_waitcnt lgkmcnt(4)
    v_mfma_f32_16x16x32_bf16 v[176:179], v[232:235], v[32:35], v[176:179]
    v_mfma_f32_16x16x32_bf16 v[180:183], v[232:235], v[36:39], v[180:183]
    v_mfma_f32_16x16x32_bf16 v[184:187], v[232:235], v[40:43], v[184:187]
    v_mfma_f32_16x16x32_bf16 v[188:191], v[232:235], v[44:47], v[188:191]
    s_waitcnt lgkmcnt(2)
    v_mfma_f32_16x16x32_bf16 v[192:195], v[236:239], v[32:35], v[192:195]
    v_mfma_f32_16x16x32_bf16 v[196:199], v[236:239], v[36:39], v[196:199]
    v_mfma_f32_16x16x32_bf16 v[200:203], v[236:239], v[40:43], v[200:203]
    v_mfma_f32_16x16x32_bf16 v[204:207], v[236:239], v[44:47], v[204:207]
    s_waitcnt lgkmcnt(0)
    v_mfma_f32_16x16x32_bf16 v[208:211], v[240:243], v[32:35], v[208:211]
    v_mfma_f32_16x16x32_bf16 v[212:215], v[240:243], v[36:39], v[212:215]
    v_mfma_f32_16x16x32_bf16 v[216:219], v[240:243], v[40:43], v[216:219]
    v_mfma_f32_16x16x32_bf16 v[220:223], v[240:243], v[44:47], v[220:223]
    s_add_u32 m0, s34, 5120
    s_nop 0
    buffer_load_dwordx4 v4, s[20:23], s40 offen lds
    s_add_u32 m0, s34, 6144
    s_nop 0
    buffer_load_dwordx4 v5, s[20:23], s40 offen lds
    s_add_u32 m0, s34, 7168
    s_nop 0
    buffer_load_dwordx4 v6, s[20:23], s40 offen lds
    s_add_u32 m0, s34, 8192
    s_nop 0
    buffer_load_dwordx4 v7, s[20:23], s40 offen lds
    s_add_u32 m0, s34, 9216
    s_nop 0
    buffer_load_dwordx4 v8, s[20:23], s40 offen lds
    s_add_u32 s42, s41, 0
    buffer_load_dwordx4 v[32:35], v10, s[24:27], s42 offen
    s_add_u32 s42, s41, 55296
    buffer_load_dwordx4 v[36:39], v10, s[24:27], s42 offen
    s_add_u32 s42, s41, 110592
    buffer_load_dwordx4 v[40:43], v10, s[24:27], s42 offen
    s_add_u32 s42, s41, 165888
    buffer_load_dwordx4 v[44:47], v10, s[24:27], s42 offen
    s_add_u32 s40, s40, 163840
    s_add_u32 s41, s41, 256
    s_waitcnt vmcnt(18)
    ds_read_b64_tr_b16 v[224:225], v11 offset:15360
    ds_read_b64_tr_b16 v[226:227], v11 offset:16000
    ds_read_b64_tr_b16 v[228:229], v11 offset:15392
    ds_read_b64_tr_b16 v[230:231], v11 offset:16032
    ds_read_b64_tr_b16 v[232:233], v11 offset:15424
    ds_read_b64_tr_b16 v[234:235], v11 offset:16064
    ds_read_b64_tr_b16 v[236:237], v11 offset:15456
    ds_read_b64_tr_b16 v[238:239], v11 offset:16096
    ds_read_b64_tr_b16 v[240:241], v11 offset:15488
    ds_read_b64_tr_b16 v[242:243], v11 offset:16128
    s_waitcnt lgkmcnt(8)
    v_mfma_f32_16x16x32_bf16 v[144:147], v[224:227], v[48:51], v[144:147]
    v_mfma_f32_16x16x32_bf16 v[148:151], v[224:227], v[52:55], v[148:151]
    v_mfma_f32_16x16x32_bf16 v[152:155], v[224:227], v[56:59], v[152:155]
    v_mfma_f32_16x16x32_bf16 v[156:159], v[224:227], v[60:63], v[156:159]
    s_waitcnt lgkmcnt(6)
    v_mfma_f32_16x16x32_bf16 v[160:163], v[228:231], v[48:51], v[160:163]
    v_mfma_f32_16x16x32_bf16 v[164:167], v[228:231], v[52:55], v[164:167]
    v_mfma_f32_16x16x32_bf16 v[168:171], v[228:231], v[56:59], v[168:171]
    v_mfma_f32_16x16x32_bf16 v[172:175], v[228:231], v[60:63], v[172:175]
    s_waitcnt lgkmcnt(4)
    v_mfma_f32_16x16x32_bf16 v[176:179], v[232:235], v[48:51], v[176:179]
    v_mfma_f32_16x16x32_bf16 v[180:183], v[232:235], v[52:55], v[180:183]
    v_mfma_f32_16x16x32_bf16 v[184:187], v[232:235], v[56:59], v[184:187]
    v_mfma_f32_16x16x32_bf16 v[188:191], v[232:235], v[60:63], v[188:191]
    s_waitcnt lgkmcnt(2)
    v_mfma_f32_16x16x32_bf16 v[192:195], v[236:239], v[48:51], v[192:195]
    v_mfma_f32_16x16x32_bf16 v[196:199], v[236:239], v[52:55], v[196:199]
    v_mfma_f32_16x16x32_bf16 v[200:203], v[236:239], v[56:59], v[200:203]
    v_mfma_f32_16x16x32_bf16 v[204:207], v[236:239], v[60:63], v[204:207]
    s_waitcnt lgkmcnt(0)
    v_mfma_f32_16x16x32_bf16 v[208:211], v[240:243], v[48:51], v[208:211]
    v_mfma_f32_16x16x32_bf16 v[212:215], v[240:243], v[52:55], v[212:215]
    v_mfma_f32_16x16x32_bf16 v[216:219], v[240:243], v[56:59], v[216:219]
    v_mfma_f32_16x16x32_bf16 v[220:223], v[240:243], v[60:63], v[220:223]
    s_add_u32 m0, s34, 10240
    s_nop 0
    buffer_load_dwordx4 v4, s[20:23], s40 offen lds
    s_add_u32 m0, s34, 11264
    s_nop 0
    buffer_load_dwordx4 v5, s[20:23], s40 offen lds
    s_add_u32 m0, s34, 12288
    s_nop 0
    buffer_load_dwordx4 v6, s[20:23], s40 offen lds
    s_add_u32 m0, s34, 13312
    s_nop 0
    buffer_load_dwordx4 v7, s[20:23], s40 offen lds
    s_add_u32 m0, s34, 14336
    s_nop 0
    buffer_load_dwordx4 v8, s[20:23], s40 offen lds
    s_add_u32 s42, s41, 0
    buffer_load_dwordx4 v[48:51], v10, s[24:27], s42 offen
    s_add_u32 s42, s41, 55296
    buffer_load_dwordx4 v[52:55], v10, s[24:27], s42 offen
    s_add_u32 s42, s41, 110592
    buffer_load_dwordx4 v[56:59], v10, s[24:27], s42 offen
    s_add_u32 s42, s41, 165888
    buffer_load_dwordx4 v[60:63], v10, s[24:27], s42 offen
    s_add_u32 s40, s40, 163840
    s_add_u32 s41, s41, 256
    s_waitcnt vmcnt(18)
    ds_read_b64_tr_b16 v[224:225], v11 offset:0
    ds_read_b64_tr_b16 v[226:227], v11 offset:640
    ds_read_b64_tr_b16 v[228:229], v11 offset:32
    ds_read_b64_tr_b16 v[230:231], v11 offset:672
    ds_read_b64_tr_b16 v[232:233], v11 offset:64
    ds_read_b64_tr_b16 v[234:235], v11 offset:704
    ds_read_b64_tr_b16 v[236:237], v11 offset:96
    ds_read_b64_tr_b16 v[238:239], v11 offset:736
    ds_read_b64_tr_b16 v[240:241], v11 offset:128
    ds_read_b64_tr_b16 v[242:243], v11 offset:768
    s_waitcnt lgkmcnt(8)
    v_mfma_f32_16x16x32_bf16 v[144:147], v[224:227], v[16:19], v[144:147]
    v_mfma_f32_16x16x32_bf16 v[148:151], v[224:227], v[20:23], v[148:151]
    v_mfma_f32_16x16x32_bf16 v[152:155], v[224:227], v[24:27], v[152:155]
    v_mfma_f32_16x16x32_bf16 v[156:159], v[224:227], v[28:31], v[156:159]
    s_waitcnt lgkmcnt(6)
    v_mfma_f32_16x16x32_bf16 v[160:163], v[228:231], v[16:19], v[160:163]
    v_mfma_f32_16x16x32_bf16 v[164:167], v[228:231], v[20:23], v[164:167]
    v_mfma_f32_16x16x32_bf16 v[168:171], v[228:231], v[24:27], v[168:171]
    v_mfma_f32_16x16x32_bf16 v[172:175], v[228:231], v[28:31], v[172:175]
    s_waitcnt lgkmcnt(4)
    v_mfma_f32_16x16x32_bf16 v[176:179], v[232:235], v[16:19], v[176:179]
    v_mfma_f32_16x16x32_bf16 v[180:183], v[232:235], v[20:23], v[180:183]
    v_mfma_f32_16x16x32_bf16 v[184:187], v[232:235], v[24:27], v[184:187]
    v_mfma_f32_16x16x32_bf16 v[188:191], v[232:235], v[28:31], v[188:191]
    s_waitcnt lgkmcnt(2)
    v_mfma_f32_16x16x32_bf16 v[192:195], v[236:239], v[16:19], v[192:195]
    v_mfma_f32_16x16x32_bf16 v[196:199], v[236:239], v[20:23], v[196:199]
    v_mfma_f32_16x16x32_bf16 v[200:203], v[236:239], v[24:27], v[200:203]
    v_mfma_f32_16x16x32_bf16 v[204:207], v[236:239], v[28:31], v[204:207]
    s_waitcnt lgkmcnt(0)
    v_mfma_f32_16x16x32_bf16 v[208:211], v[240:243], v[16:19], v[208:211]
    v_mfma_f32_16x16x32_bf16 v[212:215], v[240:243], v[20:23], v[212:215]
    v_mfma_f32_16x16x32_bf16 v[216:219], v[240:243], v[24:27], v[216:219]
    v_mfma_f32_16x16x32_bf16 v[220:223], v[240:243], v[28:31], v[220:223]
    s_add_u32 m0, s34, 15360
    s_nop 0
    buffer_load_dwordx4 v4, s[20:23], s40 offen lds
    s_add_u32 m0, s34, 16384
    s_nop 0
    buffer_load_dwordx4 v5, s[20:23], s40 offen lds
    s_add_u32 m0, s34, 17408
    s_nop 0
    buffer_load_dwordx4 v6, s[20:23], s40 offen lds
    s_add_u32 m0, s34, 18432
    s_nop 0
    buffer_load_dwordx4 v7, s[20:23], s40 offen lds
    s_add_u32 m0, s34, 19456
    s_nop 0
    buffer_load_dwordx4 v8, s[20:23], s40 offen lds
    s_add_u32 s42, s41, 0
    buffer_load_dwordx4 v[16:19], v10, s[24:27], s42 offen
    s_add_u32 s42, s41, 55296
    buffer_load_dwordx4 v[20:23], v10, s[24:27], s42 offen
    s_add_u32 s42, s41, 110592
    buffer_load_dwordx4 v[24:27], v10, s[24:27], s42 offen
    s_add_u32 s42, s41, 165888
    buffer_load_dwordx4 v[28:31], v10, s[24:27], s42 offen
    s_add_u32 s40, s40, 163840
    s_add_u32 s41, s41, 256
    s_waitcnt vmcnt(18)
    ds_read_b64_tr_b16 v[224:225], v11 offset:5120
    ds_read_b64_tr_b16 v[226:227], v11 offset:5760
    ds_read_b64_tr_b16 v[228:229], v11 offset:5152
    ds_read_b64_tr_b16 v[230:231], v11 offset:5792
    ds_read_b64_tr_b16 v[232:233], v11 offset:5184
    ds_read_b64_tr_b16 v[234:235], v11 offset:5824
    ds_read_b64_tr_b16 v[236:237], v11 offset:5216
    ds_read_b64_tr_b16 v[238:239], v11 offset:5856
    ds_read_b64_tr_b16 v[240:241], v11 offset:5248
    ds_read_b64_tr_b16 v[242:243], v11 offset:5888
    s_waitcnt lgkmcnt(8)
    v_mfma_f32_16x16x32_bf16 v[144:147], v[224:227], v[32:35], v[144:147]
    v_mfma_f32_16x16x32_bf16 v[148:151], v[224:227], v[36:39], v[148:151]
    v_mfma_f32_16x16x32_bf16 v[152:155], v[224:227], v[40:43], v[152:155]
    v_mfma_f32_16x16x32_bf16 v[156:159], v[224:227], v[44:47], v[156:159]
    s_waitcnt lgkmcnt(6)
    v_mfma_f32_16x16x32_bf16 v[160:163], v[228:231], v[32:35], v[160:163]
    v_mfma_f32_16x16x32_bf16 v[164:167], v[228:231], v[36:39], v[164:167]
    v_mfma_f32_16x16x32_bf16 v[168:171], v[228:231], v[40:43], v[168:171]
    v_mfma_f32_16x16x32_bf16 v[172:175], v[228:231], v[44:47], v[172:175]
    s_waitcnt lgkmcnt(4)
    v_mfma_f32_16x16x32_bf16 v[176:179], v[232:235], v[32:35], v[176:179]
    v_mfma_f32_16x16x32_bf16 v[180:183], v[232:235], v[36:39], v[180:183]
    v_mfma_f32_16x16x32_bf16 v[184:187], v[232:235], v[40:43], v[184:187]
    v_mfma_f32_16x16x32_bf16 v[188:191], v[232:235], v[44:47], v[188:191]
    s_waitcnt lgkmcnt(2)
    v_mfma_f32_16x16x32_bf16 v[192:195], v[236:239], v[32:35], v[192:195]
    v_mfma_f32_16x16x32_bf16 v[196:199], v[236:239], v[36:39], v[196:199]
    v_mfma_f32_16x16x32_bf16 v[200:203], v[236:239], v[40:43], v[200:203]
    v_mfma_f32_16x16x32_bf16 v[204:207], v[236:239], v[44:47], v[204:207]
    s_waitcnt lgkmcnt(0)
    v_mfma_f32_16x16x32_bf16 v[208:211], v[240:243], v[32:35], v[208:211]
    v_mfma_f32_16x16x32_bf16 v[212:215], v[240:243], v[36:39], v[212:215]
    v_mfma_f32_16x16x32_bf16 v[216:219], v[240:243], v[40:43], v[216:219]
    v_mfma_f32_16x16x32_bf16 v[220:223], v[240:243], v[44:47], v[220:223]
    s_add_u32 m0, s34, 0
    s_nop 0
    buffer_load_dwordx4 v4, s[20:23], s40 offen lds
    s_add_u32 m0, s34, 1024
    s_nop 0
    buffer_load_dwordx4 v5, s[20:23], s40 offen lds
    s_add_u32 m0, s34, 2048
    s_nop 0
    buffer_load_dwordx4 v6, s[20:23], s40 offen lds
    s_add_u32 m0, s34, 3072
    s_nop 0
    buffer_load_dwordx4 v7, s[20:23], s40 offen lds
    s_add_u32 m0, s34, 4096
    s_nop 0
    buffer_load_dwordx4 v8, s[20:23], s40 offen lds
    s_add_u32 s42, s41, 0
    buffer_load_dwordx4 v[32:35], v10, s[24:27], s42 offen
    s_add_u32 s42, s41, 55296
    buffer_load_dwordx4 v[36:39], v10, s[24:27], s42 offen
    s_add_u32 s42, s41, 110592
    buffer_load_dwordx4 v[40:43], v10, s[24:27], s42 offen
    s_add_u32 s42, s41, 165888
    buffer_load_dwordx4 v[44:47], v10, s[24:27], s42 offen
    s_add_u32 s40, s40, 163840
    s_add_u32 s41, s41, 256
    s_waitcnt vmcnt(18)
    ds_read_b64_tr_b16 v[224:225], v11 offset:10240
    ds_read_b64_tr_b16 v[226:227], v11 offset:10880
    ds_read_b64_tr_b16 v[228:229], v11 offset:10272
    ds_read_b64_tr_b16 v[230:231], v11 offset:10912
    ds_read_b64_tr_b16 v[232:233], v11 offset:10304
    ds_read_b64_tr_b16 v[234:235], v11 offset:10944
    ds_read_b64_tr_b16 v[236:237], v11 offset:10336
    ds_read_b64_tr_b16 v[238:239], v11 offset:10976
    ds_read_b64_tr_b16 v[240:241], v11 offset:10368
    ds_read_b64_tr_b16 v[242:243], v11 offset:11008
    s_waitcnt lgkmcnt(8)
    v_mfma_f32_16x16x32_bf16 v[144:147], v[224:227], v[48:51], v[144:147]
    v_mfma_f32_16x16x32_bf16 v[148:151], v[224:227], v[52:55], v[148:151]
    v_mfma_f32_16x16x32_bf16 v[152:155], v[224:227], v[56:59], v[152:155]
    v_mfma_f32_16x16x32_bf16 v[156:159], v[224:227], v[60:63], v[156:159]
    s_waitcnt lgkmcnt(6)
    v_mfma_f32_16x16x32_bf16 v[160:163], v[228:231], v[48:51], v[160:163]
    v_mfma_f32_16x16x32_bf16 v[164:167], v[228:231], v[52:55], v[164:167]
    v_mfma_f32_16x16x32_bf16 v[168:171], v[228:231], v[56:59], v[168:171]
    v_mfma_f32_16x16x32_bf16 v[172:175], v[228:231], v[60:63], v[172:175]
    s_waitcnt lgkmcnt(4)
    v_mfma_f32_16x16x32_bf16 v[176:179], v[232:235], v[48:51], v[176:179]
    v_mfma_f32_16x16x32_bf16 v[180:183], v[232:235], v[52:55], v[180:183]
    v_mfma_f32_16x16x32_bf16 v[184:187], v[232:235], v[56:59], v[184:187]
    v_mfma_f32_16x16x32_bf16 v[188:191], v[232:235], v[60:63], v[188:191]
    s_waitcnt lgkmcnt(2)
    v_mfma_f32_16x16x32_bf16 v[192:195], v[236:239], v[48:51], v[192:195]
    v_mfma_f32_16x16x32_bf16 v[196:199], v[236:239], v[52:55], v[196:199]
    v_mfma_f32_16x16x32_bf16 v[200:203], v[236:239], v[56:59], v[200:203]
    v_mfma_f32_16x16x32_bf16 v[204:207], v[236:239], v[60:63], v[204:207]
    s_waitcnt lgkmcnt(0)
    v_mfma_f32_16x16x32_bf16 v[208:211], v[240:243], v[48:51], v[208:211]
    v_mfma_f32_16x16x32_bf16 v[212:215], v[240:243], v[52:55], v[212:215]
    v_mfma_f32_16x16x32_bf16 v[216:219], v[240:243], v[56:59], v[216:219]
    v_mfma_f32_16x16x32_bf16 v[220:223], v[240:243], v[60:63], v[220:223]
    s_add_u32 m0, s34, 5120
    s_nop 0
    buffer_load_dwordx4 v4, s[20:23], s40 offen lds
    s_add_u32 m0, s34, 6144
    s_nop 0
    buffer_load_dwordx4 v5, s[20:23], s40 offen lds
    s_add_u32 m0, s34, 7168
    s_nop 0
    buffer_load_dwordx4 v6, s[20:23], s40 offen lds
    s_add_u32 m0, s34, 8192
    s_nop 0
    buffer_load_dwordx4 v7, s[20:23], s40 offen lds
    s_add_u32 m0, s34, 9216
    s_nop 0
    buffer_load_dwordx4 v8, s[20:23], s40 offen lds
    s_add_u32 s42, s41, 0
    buffer_load_dwordx4 v[48:51], v10, s[24:27], s42 offen
    s_add_u32 s42, s41, 55296
    buffer_load_dwordx4 v[52:55], v10, s[24:27], s42 offen
    s_add_u32 s42, s41, 110592
    buffer_load_dwordx4 v[56:59], v10, s[24:27], s42 offen
    s_add_u32 s42, s41, 165888
    buffer_load_dwordx4 v[60:63], v10, s[24:27], s42 offen
    s_add_u32 s40, s40, 163840
    s_add_u32 s41, s41, 256
    s_waitcnt vmcnt(18)
    ds_read_b64_tr_b16 v[224:225], v11 offset:15360
    ds_read_b64_tr_b16 v[226:227], v11 offset:16000
    ds_read_b64_tr_b16 v[228:229], v11 offset:15392
    ds_read_b64_tr_b16 v[230:231], v11 offset:16032
    ds_read_b64_tr_b16 v[232:233], v11 offset:15424
    ds_read_b64_tr_b16 v[234:235], v11 offset:16064
    ds_read_b64_tr_b16 v[236:237], v11 offset:15456
    ds_read_b64_tr_b16 v[238:239], v11 offset:16096
    ds_read_b64_tr_b16 v[240:241], v11 offset:15488
    ds_read_b64_tr_b16 v[242:243], v11 offset:16128
    s_waitcnt lgkmcnt(8)
    v_mfma_f32_16x16x32_bf16 v[144:147], v[224:227], v[16:19], v[144:147]
    v_mfma_f32_16x16x32_bf16 v[148:151], v[224:227], v[20:23], v[148:151]
    v_mfma_f32_16x16x32_bf16 v[152:155], v[224:227], v[24:27], v[152:155]
    v_mfma_f32_16x16x32_bf16 v[156:159], v[224:227], v[28:31], v[156:159]
    s_waitcnt lgkmcnt(6)
    v_mfma_f32_16x16x32_bf16 v[160:163], v[228:231], v[16:19], v[160:163]
    v_mfma_f32_16x16x32_bf16 v[164:167], v[228:231], v[20:23], v[164:167]
    v_mfma_f32_16x16x32_bf16 v[168:171], v[228:231], v[24:27], v[168:171]
    v_mfma_f32_16x16x32_bf16 v[172:175], v[228:231], v[28:31], v[172:175]
    s_waitcnt lgkmcnt(4)
    v_mfma_f32_16x16x32_bf16 v[176:179], v[232:235], v[16:19], v[176:179]
    v_mfma_f32_16x16x32_bf16 v[180:183], v[232:235], v[20:23], v[180:183]
    v_mfma_f32_16x16x32_bf16 v[184:187], v[232:235], v[24:27], v[184:187]
    v_mfma_f32_16x16x32_bf16 v[188:191], v[232:235], v[28:31], v[188:191]
    s_waitcnt lgkmcnt(2)
    v_mfma_f32_16x16x32_bf16 v[192:195], v[236:239], v[16:19], v[192:195]
    v_mfma_f32_16x16x32_bf16 v[196:199], v[236:239], v[20:23], v[196:199]
    v_mfma_f32_16x16x32_bf16 v[200:203], v[236:239], v[24:27], v[200:203]
    v_mfma_f32_16x16x32_bf16 v[204:207], v[236:239], v[28:31], v[204:207]
    s_waitcnt lgkmcnt(0)
    v_mfma_f32_16x16x32_bf16 v[208:211], v[240:243], v[16:19], v[208:211]
    v_mfma_f32_16x16x32_bf16 v[212:215], v[240:243], v[20:23], v[212:215]
    v_mfma_f32_16x16x32_bf16 v[216:219], v[240:243], v[24:27], v[216:219]
    v_mfma_f32_16x16x32_bf16 v[220:223], v[240:243], v[28:31], v[220:223]
    s_add_u32 m0, s34, 10240
    s_nop 0
    buffer_load_dwordx4 v4, s[20:23], s40 offen lds
    s_add_u32 m0, s34, 11264
    s_nop 0
    buffer_load_dwordx4 v5, s[20:23], s40 offen lds
    s_add_u32 m0, s34, 12288
    s_nop 0
    buffer_load_dwordx4 v6, s[20:23], s40 offen lds
    s_add_u32 m0, s34, 13312
    s_nop 0
    buffer_load_dwordx4 v7, s[20:23], s40 offen lds
    s_add_u32 m0, s34, 14336
    s_nop 0
    buffer_load_dwordx4 v8, s[20:23], s40 offen lds
    s_add_u32 s42, s41, 0
    buffer_load_dwordx4 v[16:19], v10, s[24:27], s42 offen
    s_add_u32 s42, s41, 55296
    buffer_load_dwordx4 v[20:23], v10, s[24:27], s42 offen
    s_add_u32 s42, s41, 110592
    buffer_load_dwordx4 v[24:27], v10, s[24:27], s42 offen
    s_add_u32 s42, s41, 165888
    buffer_load_dwordx4 v[28:31], v10, s[24:27], s42 offen
    s_add_u32 s40, s40, 163840
    s_add_u32 s41, s41, 256
    s_waitcnt vmcnt(18)
    ds_read_b64_tr_b16 v[224:225], v11 offset:0
    ds_read_b64_tr_b16 v[226:227], v11 offset:640
    ds_read_b64_tr_b16 v[228:229], v11 offset:32
    ds_read_b64_tr_b16 v[230:231], v11 offset:672
    ds_read_b64_tr_b16 v[232:233], v11 offset:64
    ds_read_b64_tr_b16 v[234:235], v11 offset:704
    ds_read_b64_tr_b16 v[236:237], v11 offset:96
    ds_read_b64_tr_b16 v[238:239], v11 offset:736
    ds_read_b64_tr_b16 v[240:241], v11 offset:128
    ds_read_b64_tr_b16 v[242:243], v11 offset:768
    s_waitcnt lgkmcnt(8)
    v_mfma_f32_16x16x32_bf16 v[144:147], v[224:227], v[32:35], v[144:147]
    v_mfma_f32_16x16x32_bf16 v[148:151], v[224:227], v[36:39], v[148:151]
    v_mfma_f32_16x16x32_bf16 v[152:155], v[224:227], v[40:43], v[152:155]
    v_mfma_f32_16x16x32_bf16 v[156:159], v[224:227], v[44:47], v[156:159]
    s_waitcnt lgkmcnt(6)
    v_mfma_f32_16x16x32_bf16 v[160:163], v[228:231], v[32:35], v[160:163]
    v_mfma_f32_16x16x32_bf16 v[164:167], v[228:231], v[36:39], v[164:167]
    v_mfma_f32_16x16x32_bf16 v[168:171], v[228:231], v[40:43], v[168:171]
    v_mfma_f32_16x16x32_bf16 v[172:175], v[228:231], v[44:47], v[172:175]
    s_waitcnt lgkmcnt(4)
    v_mfma_f32_16x16x32_bf16 v[176:179], v[232:235], v[32:35], v[176:179]
    v_mfma_f32_16x16x32_bf16 v[180:183], v[232:235], v[36:39], v[180:183]
    v_mfma_f32_16x16x32_bf16 v[184:187], v[232:235], v[40:43], v[184:187]
    v_mfma_f32_16x16x32_bf16 v[188:191], v[232:235], v[44:47], v[188:191]
    s_waitcnt lgkmcnt(2)
    v_mfma_f32_16x16x32_bf16 v[192:195], v[236:239], v[32:35], v[192:195]
    v_mfma_f32_16x16x32_bf16 v[196:199], v[236:239], v[36:39], v[196:199]
    v_mfma_f32_16x16x32_bf16 v[200:203], v[236:239], v[40:43], v[200:203]
    v_mfma_f32_16x16x32_bf16 v[204:207], v[236:239], v[44:47], v[204:207]
    s_waitcnt lgkmcnt(0)
    v_mfma_f32_16x16x32_bf16 v[208:211], v[240:243], v[32:35], v[208:211]
    v_mfma_f32_16x16x32_bf16 v[212:215], v[240:243], v[36:39], v[212:215]
    v_mfma_f32_16x16x32_bf16 v[216:219], v[240:243], v[40:43], v[216:219]
    v_mfma_f32_16x16x32_bf16 v[220:223], v[240:243], v[44:47], v[220:223]
    s_waitcnt vmcnt(9)
    ds_read_b64_tr_b16 v[224:225], v11 offset:5120
    ds_read_b64_tr_b16 v[226:227], v11 offset:5760
    ds_read_b64_tr_b16 v[228:229], v11 offset:5152
    ds_read_b64_tr_b16 v[230:231], v11 offset:5792
    ds_read_b64_tr_b16 v[232:233], v11 offset:5184
    ds_read_b64_tr_b16 v[234:235], v11 offset:5824
    ds_read_b64_tr_b16 v[236:237], v11 offset:5216
    ds_read_b64_tr_b16 v[238:239], v11 offset:5856
    ds_read_b64_tr_b16 v[240:241], v11 offset:5248
    ds_read_b64_tr_b16 v[242:243], v11 offset:5888
    s_waitcnt lgkmcnt(8)
    v_mfma_f32_16x16x32_bf16 v[144:147], v[224:227], v[48:51], v[144:147]
    v_mfma_f32_16x16x32_bf16 v[148:151], v[224:227], v[52:55], v[148:151]
    v_mfma_f32_16x16x32_bf16 v[152:155], v[224:227], v[56:59], v[152:155]
    v_mfma_f32_16x16x32_bf16 v[156:159], v[224:227], v[60:63], v[156:159]
    s_waitcnt lgkmcnt(6)
    v_mfma_f32_16x16x32_bf16 v[160:163], v[228:231], v[48:51], v[160:163]
    v_mfma_f32_16x16x32_bf16 v[164:167], v[228:231], v[52:55], v[164:167]
    v_mfma_f32_16x16x32_bf16 v[168:171], v[228:231], v[56:59], v[168:171]
    v_mfma_f32_16x16x32_bf16 v[172:175], v[228:231], v[60:63], v[172:175]
    s_waitcnt lgkmcnt(4)
    v_mfma_f32_16x16x32_bf16 v[176:179], v[232:235], v[48:51], v[176:179]
    v_mfma_f32_16x16x32_bf16 v[180:183], v[232:235], v[52:55], v[180:183]
    v_mfma_f32_16x16x32_bf16 v[184:187], v[232:235], v[56:59], v[184:187]
    v_mfma_f32_16x16x32_bf16 v[188:191], v[232:235], v[60:63], v[188:191]
    s_waitcnt lgkmcnt(2)
    v_mfma_f32_16x16x32_bf16 v[192:195], v[236:239], v[48:51], v[192:195]
    v_mfma_f32_16x16x32_bf16 v[196:199], v[236:239], v[52:55], v[196:199]
    v_mfma_f32_16x16x32_bf16 v[200:203], v[236:239], v[56:59], v[200:203]
    v_mfma_f32_16x16x32_bf16 v[204:207], v[236:239], v[60:63], v[204:207]
    s_waitcnt lgkmcnt(0)
    v_mfma_f32_16x16x32_bf16 v[208:211], v[240:243], v[48:51], v[208:211]
    v_mfma_f32_16x16x32_bf16 v[212:215], v[240:243], v[52:55], v[212:215]
    v_mfma_f32_16x16x32_bf16 v[216:219], v[240:243], v[56:59], v[216:219]
    v_mfma_f32_16x16x32_bf16 v[220:223], v[240:243], v[60:63], v[220:223]
    s_waitcnt vmcnt(0)
    ds_read_b64_tr_b16 v[224:225], v11 offset:10240
    ds_read_b64_tr_b16 v[226:227], v11 offset:10880
    ds_read_b64_tr_b16 v[228:229], v11 offset:10272
    ds_read_b64_tr_b16 v[230:231], v11 offset:10912
    ds_read_b64_tr_b16 v[232:233], v11 offset:10304
    ds_read_b64_tr_b16 v[234:235], v11 offset:10944
    ds_read_b64_tr_b16 v[236:237], v11 offset:10336
    ds_read_b64_tr_b16 v[238:239], v11 offset:10976
    ds_read_b64_tr_b16 v[240:241], v11 offset:10368
    ds_read_b64_tr_b16 v[242:243], v11 offset:11008
    s_cmp_ge_u32 s30, 2
    s_cbranch_scc1 k3_kernel_skiplast
    s_waitcnt lgkmcnt(8)
    v_mfma_f32_16x16x32_bf16 v[144:147], v[224:227], v[16:19], v[144:147]
    v_mfma_f32_16x16x32_bf16 v[148:151], v[224:227], v[20:23], v[148:151]
    v_mfma_f32_16x16x32_bf16 v[152:155], v[224:227], v[24:27], v[152:155]
    v_mfma_f32_16x16x32_bf16 v[156:159], v[224:227], v[28:31], v[156:159]
    s_waitcnt lgkmcnt(6)
    v_mfma_f32_16x16x32_bf16 v[160:163], v[228:231], v[16:19], v[160:163]
    v_mfma_f32_16x16x32_bf16 v[164:167], v[228:231], v[20:23], v[164:167]
    v_mfma_f32_16x16x32_bf16 v[168:171], v[228:231], v[24:27], v[168:171]
    v_mfma_f32_16x16x32_bf16 v[172:175], v[228:231], v[28:31], v[172:175]
    s_waitcnt lgkmcnt(4)
    v_mfma_f32_16x16x32_bf16 v[176:179], v[232:235], v[16:19], v[176:179]
    v_mfma_f32_16x16x32_bf16 v[180:183], v[232:235], v[20:23], v[180:183]
    v_mfma_f32_16x16x32_bf16 v[184:187], v[232:235], v[24:27], v[184:187]
    v_mfma_f32_16x16x32_bf16 v[188:191], v[232:235], v[28:31], v[188:191]
    s_waitcnt lgkmcnt(2)
    v_mfma_f32_16x16x32_bf16 v[192:195], v[236:239], v[16:19], v[192:195]
    v_mfma_f32_16x16x32_bf16 v[196:199], v[236:239], v[20:23], v[196:199]
    v_mfma_f32_16x16x32_bf16 v[200:203], v[236:239], v[24:27], v[200:203]
    v_mfma_f32_16x16x32_bf16 v[204:207], v[236:239], v[28:31], v[204:207]
    s_waitcnt lgkmcnt(0)
    v_mfma_f32_16x16x32_bf16 v[208:211], v[240:243], v[16:19], v[208:211]
    v_mfma_f32_16x16x32_bf16 v[212:215], v[240:243], v[20:23], v[212:215]
    v_mfma_f32_16x16x32_bf16 v[216:219], v[240:243], v[24:27], v[216:219]
    v_mfma_f32_16x16x32_bf16 v[220:223], v[240:243], v[28:31], v[220:223]
    k3_kernel_skiplast:
    s_waitcnt lgkmcnt(0)
    s_nop 7
    s_nop 7
    s_barrier
    v_lshlrev_b32 v12, 4, v1
    s_add_u32 s42, s30, 1
    s_and_b32 s42, s42, 3
    s_mul_i32 s43, s42, 30720
    s_add_u32 s43, s43, 0
    v_add_u32 v13, s43, v12
    s_cmp_lg_u32 s42, 0
    s_cbranch_scc1 k3_kernel_w1_0
    ds_write_b128 v13, v[64:67] offset:0
    ds_write_b128 v13, v[80:83] offset:1024
    ds_write_b128 v13, v[96:99] offset:2048
    ds_write_b128 v13, v[112:115] offset:3072
    ds_write_b128 v13, v[128:131] offset:4096
    ds_write_b128 v13, v[144:147] offset:5120
    ds_write_b128 v13, v[160:163] offset:6144
    ds_write_b128 v13, v[176:179] offset:7168
    ds_write_b128 v13, v[192:195] offset:8192
    ds_write_b128 v13, v[208:211] offset:9216
k3_kernel_w1_0:
    s_cmp_lg_u32 s42, 1
    s_cbranch_scc1 k3_kernel_w1_1
    ds_write_b128 v13, v[68:71] offset:0
    ds_write_b128 v13, v[84:87] offset:1024
    ds_write_b128 v13, v[100:103] offset:2048
    ds_write_b128 v13, v[116:119] offset:3072
    ds_write_b128 v13, v[132:135] offset:4096
    ds_write_b128 v13, v[148:151] offset:5120
    ds_write_b128 v13, v[164:167] offset:6144
    ds_write_b128 v13, v[180:183] offset:7168
    ds_write_b128 v13, v[196:199] offset:8192
    ds_write_b128 v13, v[212:215] offset:9216
k3_kernel_w1_1:
    s_cmp_lg_u32 s42, 2
    s_cbranch_scc1 k3_kernel_w1_2
    ds_write_b128 v13, v[72:75] offset:0
    ds_write_b128 v13, v[88:91] offset:1024
    ds_write_b128 v13, v[104:107] offset:2048
    ds_write_b128 v13, v[120:123] offset:3072
    ds_write_b128 v13, v[136:139] offset:4096
    ds_write_b128 v13, v[152:155] offset:5120
    ds_write_b128 v13, v[168:171] offset:6144
    ds_write_b128 v13, v[184:187] offset:7168
    ds_write_b128 v13, v[200:203] offset:8192
    ds_write_b128 v13, v[216:219] offset:9216
k3_kernel_w1_2:
    s_cmp_lg_u32 s42, 3
    s_cbranch_scc1 k3_kernel_w1_3
    ds_write_b128 v13, v[76:79] offset:0
    ds_write_b128 v13, v[92:95] offset:1024
    ds_write_b128 v13, v[108:111] offset:2048
    ds_write_b128 v13, v[124:127] offset:3072
    ds_write_b128 v13, v[140:143] offset:4096
    ds_write_b128 v13, v[156:159] offset:5120
    ds_write_b128 v13, v[172:175] offset:6144
    ds_write_b128 v13, v[188:191] offset:7168
    ds_write_b128 v13, v[204:207] offset:8192
    ds_write_b128 v13, v[220:223] offset:9216
k3_kernel_w1_3:
    s_add_u32 s42, s30, 2
    s_and_b32 s42, s42, 3
    s_mul_i32 s43, s42, 30720
    s_add_u32 s43, s43, 10240
    v_add_u32 v13, s43, v12
    s_cmp_lg_u32 s42, 0
    s_cbranch_scc1 k3_kernel_w2_0
    ds_write_b128 v13, v[64:67] offset:0
    ds_write_b128 v13, v[80:83] offset:1024
    ds_write_b128 v13, v[96:99] offset:2048
    ds_write_b128 v13, v[112:115] offset:3072
    ds_write_b128 v13, v[128:131] offset:4096
    ds_write_b128 v13, v[144:147] offset:5120
    ds_write_b128 v13, v[160:163] offset:6144
    ds_write_b128 v13, v[176:179] offset:7168
    ds_write_b128 v13, v[192:195] offset:8192
    ds_write_b128 v13, v[208:211] offset:9216
k3_kernel_w2_0:
    s_cmp_lg_u32 s42, 1
    s_cbranch_scc1 k3_kernel_w2_1
    ds_write_b128 v13, v[68:71] offset:0
    ds_write_b128 v13, v[84:87] offset:1024
    ds_write_b128 v13, v[100:103] offset:2048
    ds_write_b128 v13, v[116:119] offset:3072
    ds_write_b128 v13, v[132:135] offset:4096
    ds_write_b128 v13, v[148:151] offset:5120
    ds_write_b128 v13, v[164:167] offset:6144
    ds_write_b128 v13, v[180:183] offset:7168
    ds_write_b128 v13, v[196:199] offset:8192
    ds_write_b128 v13, v[212:215] offset:9216
k3_kernel_w2_1:
    s_cmp_lg_u32 s42, 2
    s_cbranch_scc1 k3_kernel_w2_2
    ds_write_b128 v13, v[72:75] offset:0
    ds_write_b128 v13, v[88:91] offset:1024
    ds_write_b128 v13, v[104:107] offset:2048
    ds_write_b128 v13, v[120:123] offset:3072
    ds_write_b128 v13, v[136:139] offset:4096
    ds_write_b128 v13, v[152:155] offset:5120
    ds_write_b128 v13, v[168:171] offset:6144
    ds_write_b128 v13, v[184:187] offset:7168
    ds_write_b128 v13, v[200:203] offset:8192
    ds_write_b128 v13, v[216:219] offset:9216
k3_kernel_w2_2:
    s_cmp_lg_u32 s42, 3
    s_cbranch_scc1 k3_kernel_w2_3
    ds_write_b128 v13, v[76:79] offset:0
    ds_write_b128 v13, v[92:95] offset:1024
    ds_write_b128 v13, v[108:111] offset:2048
    ds_write_b128 v13, v[124:127] offset:3072
    ds_write_b128 v13, v[140:143] offset:4096
    ds_write_b128 v13, v[156:159] offset:5120
    ds_write_b128 v13, v[172:175] offset:6144
    ds_write_b128 v13, v[188:191] offset:7168
    ds_write_b128 v13, v[204:207] offset:8192
    ds_write_b128 v13, v[220:223] offset:9216
k3_kernel_w2_3:
    s_add_u32 s42, s30, 3
    s_and_b32 s42, s42, 3
    s_mul_i32 s43, s42, 30720
    s_add_u32 s43, s43, 20480
    v_add_u32 v13, s43, v12
    s_cmp_lg_u32 s42, 0
    s_cbranch_scc1 k3_kernel_w3_0
    ds_write_b128 v13, v[64:67] offset:0
    ds_write_b128 v13, v[80:83] offset:1024
    ds_write_b128 v13, v[96:99] offset:2048
    ds_write_b128 v13, v[112:115] offset:3072
    ds_write_b128 v13, v[128:131] offset:4096
    ds_write_b128 v13, v[144:147] offset:5120
    ds_write_b128 v13, v[160:163] offset:6144
    ds_write_b128 v13, v[176:179] offset:7168
    ds_write_b128 v13, v[192:195] offset:8192
    ds_write_b128 v13, v[208:211] offset:9216
k3_kernel_w3_0:
    s_cmp_lg_u32 s42, 1
    s_cbranch_scc1 k3_kernel_w3_1
    ds_write_b128 v13, v[68:71] offset:0
    ds_write_b128 v13, v[84:87] offset:1024
    ds_write_b128 v13, v[100:103] offset:2048
    ds_write_b128 v13, v[116:119] offset:3072
    ds_write_b128 v13, v[132:135] offset:4096
    ds_write_b128 v13, v[148:151] offset:5120
    ds_write_b128 v13, v[164:167] offset:6144
    ds_write_b128 v13, v[180:183] offset:7168
    ds_write_b128 v13, v[196:199] offset:8192
    ds_write_b128 v13, v[212:215] offset:9216
k3_kernel_w3_1:
    s_cmp_lg_u32 s42, 2
    s_cbranch_scc1 k3_kernel_w3_2
    ds_write_b128 v13, v[72:75] offset:0
    ds_write_b128 v13, v[88:91] offset:1024
    ds_write_b128 v13, v[104:107] offset:2048
    ds_write_b128 v13, v[120:123] offset:3072
    ds_write_b128 v13, v[136:139] offset:4096
    ds_write_b128 v13, v[152:155] offset:5120
    ds_write_b128 v13, v[168:171] offset:6144
    ds_write_b128 v13, v[184:187] offset:7168
    ds_write_b128 v13, v[200:203] offset:8192
    ds_write_b128 v13, v[216:219] offset:9216
k3_kernel_w3_2:
    s_cmp_lg_u32 s42, 3
    s_cbranch_scc1 k3_kernel_w3_3
    ds_write_b128 v13, v[76:79] offset:0
    ds_write_b128 v13, v[92:95] offset:1024
    ds_write_b128 v13, v[108:111] offset:2048
    ds_write_b128 v13, v[124:127] offset:3072
    ds_write_b128 v13, v[140:143] offset:4096
    ds_write_b128 v13, v[156:159] offset:5120
    ds_write_b128 v13, v[172:175] offset:6144
    ds_write_b128 v13, v[188:191] offset:7168
    ds_write_b128 v13, v[204:207] offset:8192
    ds_write_b128 v13, v[220:223] offset:9216
k3_kernel_w3_3:
    s_waitcnt lgkmcnt(0)
    s_barrier
    s_mul_i32 s43, s30, 30720
    v_add_u32 v13, s43, v12
    s_cmp_lg_u32 s30, 0
    s_cbranch_scc1 k3_kernel_o0
    v_mov_b32 v16, v64
    v_mov_b32 v17, v65
    v_mov_b32 v18, v66
    v_mov_b32 v19, v67
    v_mov_b32 v20, v80
    v_mov_b32 v21, v81
    v_mov_b32 v22, v82
    v_mov_b32 v23, v83
    v_mov_b32 v24, v96
    v_mov_b32 v25, v97
    v_mov_b32 v26, v98
    v_mov_b32 v27, v99
    v_mov_b32 v28, v112
    v_mov_b32 v29, v113
    v_mov_b32 v30, v114
    v_mov_b32 v31, v115
    v_mov_b32 v32, v128
    v_mov_b32 v33, v129
    v_mov_b32 v34, v130
    v_mov_b32 v35, v131
    v_mov_b32 v36, v144
    v_mov_b32 v37, v145
    v_mov_b32 v38, v146
    v_mov_b32 v39, v147
    v_mov_b32 v40, v160
    v_mov_b32 v41, v161
    v_mov_b32 v42, v162
    v_mov_b32 v43, v163
    v_mov_b32 v44, v176
    v_mov_b32 v45, v177
    v_mov_b32 v46, v178
    v_mov_b32 v47, v179
    v_mov_b32 v48, v192
    v_mov_b32 v49, v193
    v_mov_b32 v50, v194
    v_mov_b32 v51, v195
    v_mov_b32 v52, v208
    v_mov_b32 v53, v209
    v_mov_b32 v54, v210
    v_mov_b32 v55, v211
k3_kernel_o0:
    s_cmp_lg_u32 s30, 1
    s_cbranch_scc1 k3_kernel_o1
    v_mov_b32 v16, v68
    v_mov_b32 v17, v69
    v_mov_b32 v18, v70
    v_mov_b32 v19, v71
    v_mov_b32 v20, v84
    v_mov_b32 v21, v85
    v_mov_b32 v22, v86
    v_mov_b32 v23, v87
    v_mov_b32 v24, v100
    v_mov_b32 v25, v101
    v_mov_b32 v26, v102
    v_mov_b32 v27, v103
    v_mov_b32 v28, v116
    v_mov_b32 v29, v117
    v_mov_b32 v30, v118
    v_mov_b32 v31, v119
    v_mov_b32 v32, v132
    v_mov_b32 v33, v133
    v_mov_b32 v34, v134
    v_mov_b32 v35, v135
    v_mov_b32 v36, v148
    v_mov_b32 v37, v149
    v_mov_b32 v38, v150
    v_mov_b32 v39, v151
    v_mov_b32 v40, v164
    v_mov_b32 v41, v165
    v_mov_b32 v42, v166
    v_mov_b32 v43, v167
    v_mov_b32 v44, v180
    v_mov_b32 v45, v181
    v_mov_b32 v46, v182
    v_mov_b32 v47, v183
    v_mov_b32 v48, v196
    v_mov_b32 v49, v197
    v_mov_b32 v50, v198
    v_mov_b32 v51, v199
    v_mov_b32 v52, v212
    v_mov_b32 v53, v213
    v_mov_b32 v54, v214
    v_mov_b32 v55, v215
k3_kernel_o1:
    s_cmp_lg_u32 s30, 2
    s_cbranch_scc1 k3_kernel_o2
    v_mov_b32 v16, v72
    v_mov_b32 v17, v73
    v_mov_b32 v18, v74
    v_mov_b32 v19, v75
    v_mov_b32 v20, v88
    v_mov_b32 v21, v89
    v_mov_b32 v22, v90
    v_mov_b32 v23, v91
    v_mov_b32 v24, v104
    v_mov_b32 v25, v105
    v_mov_b32 v26, v106
    v_mov_b32 v27, v107
    v_mov_b32 v28, v120
    v_mov_b32 v29, v121
    v_mov_b32 v30, v122
    v_mov_b32 v31, v123
    v_mov_b32 v32, v136
    v_mov_b32 v33, v137
    v_mov_b32 v34, v138
    v_mov_b32 v35, v139
    v_mov_b32 v36, v152
    v_mov_b32 v37, v153
    v_mov_b32 v38, v154
    v_mov_b32 v39, v155
    v_mov_b32 v40, v168
    v_mov_b32 v41, v169
    v_mov_b32 v42, v170
    v_mov_b32 v43, v171
    v_mov_b32 v44, v184
    v_mov_b32 v45, v185
    v_mov_b32 v46, v186
    v_mov_b32 v47, v187
    v_mov_b32 v48, v200
    v_mov_b32 v49, v201
    v_mov_b32 v50, v202
    v_mov_b32 v51, v203
    v_mov_b32 v52, v216
    v_mov_b32 v53, v217
    v_mov_b32 v54, v218
    v_mov_b32 v55, v219
k3_kernel_o2:
    s_cmp_lg_u32 s30, 3
    s_cbranch_scc1 k3_kernel_o3
    v_mov_b32 v16, v76
    v_mov_b32 v17, v77
    v_mov_b32 v18, v78
    v_mov_b32 v19, v79
    v_mov_b32 v20, v92
    v_mov_b32 v21, v93
    v_mov_b32 v22, v94
    v_mov_b32 v23, v95
    v_mov_b32 v24, v108
    v_mov_b32 v25, v109
    v_mov_b32 v26, v110
    v_mov_b32 v27, v111
    v_mov_b32 v28, v124
    v_mov_b32 v29, v125
    v_mov_b32 v30, v126
    v_mov_b32 v31, v127
    v_mov_b32 v32, v140
    v_mov_b32 v33, v141
    v_mov_b32 v34, v142
    v_mov_b32 v35, v143
    v_mov_b32 v36, v156
    v_mov_b32 v37, v157
    v_mov_b32 v38, v158
    v_mov_b32 v39, v159
    v_mov_b32 v40, v172
    v_mov_b32 v41, v173
    v_mov_b32 v42, v174
    v_mov_b32 v43, v175
    v_mov_b32 v44, v188
    v_mov_b32 v45, v189
    v_mov_b32 v46, v190
    v_mov_b32 v47, v191
    v_mov_b32 v48, v204
    v_mov_b32 v49, v205
    v_mov_b32 v50, v206
    v_mov_b32 v51, v207
    v_mov_b32 v52, v220
    v_mov_b32 v53, v221
    v_mov_b32 v54, v222
    v_mov_b32 v55, v223
k3_kernel_o3:
    ds_read_b128 v[64:67], v13 offset:0
    ds_read_b128 v[68:71], v13 offset:1024
    ds_read_b128 v[72:75], v13 offset:2048
    ds_read_b128 v[76:79], v13 offset:3072
    ds_read_b128 v[80:83], v13 offset:4096
    ds_read_b128 v[84:87], v13 offset:5120
    ds_read_b128 v[88:91], v13 offset:6144
    ds_read_b128 v[92:95], v13 offset:7168
    ds_read_b128 v[96:99], v13 offset:8192
    ds_read_b128 v[100:103], v13 offset:9216
    ds_read_b128 v[104:107], v13 offset:10240
    ds_read_b128 v[108:111], v13 offset:11264
    ds_read_b128 v[112:115], v13 offset:12288
    ds_read_b128 v[116:119], v13 offset:13312
    ds_read_b128 v[120:123], v13 offset:14336
    ds_read_b128 v[124:127], v13 offset:15360
    ds_read_b128 v[128:131], v13 offset:16384
    ds_read_b128 v[132:135], v13 offset:17408
    ds_read_b128 v[136:139], v13 offset:18432
    ds_read_b128 v[140:143], v13 offset:19456
    ds_read_b128 v[144:147], v13 offset:20480
    ds_read_b128 v[148:151], v13 offset:21504
    ds_read_b128 v[152:155], v13 offset:22528
    ds_read_b128 v[156:159], v13 offset:23552
    ds_read_b128 v[160:163], v13 offset:24576
    ds_read_b128 v[164:167], v13 offset:25600
    ds_read_b128 v[168:171], v13 offset:26624
    ds_read_b128 v[172:175], v13 offset:27648
    ds_read_b128 v[176:179], v13 offset:28672
    ds_read_b128 v[180:183], v13 offset:29696
    s_lshl_b32 s42, s30, 4
    s_add_u32 s42, s42, s33
    v_and_b32 v12, 15, v1
    v_add_u32 v12, s42, v12
    v_lshlrev_b32 v14, 2, v12
    v_add_u32 v14, 20971520, v14
    buffer_load_dword v15, v14, s[24:27], 0 offen
    s_waitcnt lgkmcnt(0)
    v_add_f32 v16, v16, v64
    v_add_f32 v17, v17, v65
    v_add_f32 v18, v18, v66
    v_add_f32 v19, v19, v67
    v_add_f32 v20, v20, v68
    v_add_f32 v21, v21, v69
    v_add_f32 v22, v22, v70
    v_add_f32 v23, v23, v71
    v_add_f32 v24, v24, v72
    v_add_f32 v25, v25, v73
    v_add_f32 v26, v26, v74
    v_add_f32 v27, v27, v75
    v_add_f32 v28, v28, v76
    v_add_f32 v29, v29, v77
    v_add_f32 v30, v30, v78
    v_add_f32 v31, v31, v79
    v_add_f32 v32, v32, v80
    v_add_f32 v33, v33, v81
    v_add_f32 v34, v34, v82
    v_add_f32 v35, v35, v83
    v_add_f32 v36, v36, v84
    v_add_f32 v37, v37, v85
    v_add_f32 v38, v38, v86
    v_add_f32 v39, v39, v87
    v_add_f32 v40, v40, v88
    v_add_f32 v41, v41, v89
    v_add_f32 v42, v42, v90
    v_add_f32 v43, v43, v91
    v_add_f32 v44, v44, v92
    v_add_f32 v45, v45, v93
    v_add_f32 v46, v46, v94
    v_add_f32 v47, v47, v95
    v_add_f32 v48, v48, v96
    v_add_f32 v49, v49, v97
    v_add_f32 v50, v50, v98
    v_add_f32 v51, v51, v99
    v_add_f32 v52, v52, v100
    v_add_f32 v53, v53, v101
    v_add_f32 v54, v54, v102
    v_add_f32 v55, v55, v103
    v_add_f32 v16, v16, v104
    v_add_f32 v17, v17, v105
    v_add_f32 v18, v18, v106
    v_add_f32 v19, v19, v107
    v_add_f32 v20, v20, v108
    v_add_f32 v21, v21, v109
    v_add_f32 v22, v22, v110
    v_add_f32 v23, v23, v111
    v_add_f32 v24, v24, v112
    v_add_f32 v25, v25, v113
    v_add_f32 v26, v26, v114
    v_add_f32 v27, v27, v115
    v_add_f32 v28, v28, v116
    v_add_f32 v29, v29, v117
    v_add_f32 v30, v30, v118
    v_add_f32 v31, v31, v119
    v_add_f32 v32, v32, v120
    v_add_f32 v33, v33, v121
    v_add_f32 v34, v34, v122
    v_add_f32 v35, v35, v123
    v_add_f32 v36, v36, v124
    v_add_f32 v37, v37, v125
    v_add_f32 v38, v38, v126
    v_add_f32 v39, v39, v127
    v_add_f32 v40, v40, v128
    v_add_f32 v41, v41, v129
    v_add_f32 v42, v42, v130
    v_add_f32 v43, v43, v131
    v_add_f32 v44, v44, v132
    v_add_f32 v45, v45, v133
    v_add_f32 v46, v46, v134
    v_add_f32 v47, v47, v135
    v_add_f32 v48, v48, v136
    v_add_f32 v49, v49, v137
    v_add_f32 v50, v50, v138
    v_add_f32 v51, v51, v139
    v_add_f32 v52, v52, v140
    v_add_f32 v53, v53, v141
    v_add_f32 v54, v54, v142
    v_add_f32 v55, v55, v143
    v_add_f32 v16, v16, v144
    v_add_f32 v17, v17, v145
    v_add_f32 v18, v18, v146
    v_add_f32 v19, v19, v147
    v_add_f32 v20, v20, v148
    v_add_f32 v21, v21, v149
    v_add_f32 v22, v22, v150
    v_add_f32 v23, v23, v151
    v_add_f32 v24, v24, v152
    v_add_f32 v25, v25, v153
    v_add_f32 v26, v26, v154
    v_add_f32 v27, v27, v155
    v_add_f32 v28, v28, v156
    v_add_f32 v29, v29, v157
    v_add_f32 v30, v30, v158
    v_add_f32 v31, v31, v159
    v_add_f32 v32, v32, v160
    v_add_f32 v33, v33, v161
    v_add_f32 v34, v34, v162
    v_add_f32 v35, v35, v163
    v_add_f32 v36, v36, v164
    v_add_f32 v37, v37, v165
    v_add_f32 v38, v38, v166
    v_add_f32 v39, v39, v167
    v_add_f32 v40, v40, v168
    v_add_f32 v41, v41, v169
    v_add_f32 v42, v42, v170
    v_add_f32 v43, v43, v171
    v_add_f32 v44, v44, v172
    v_add_f32 v45, v45, v173
    v_add_f32 v46, v46, v174
    v_add_f32 v47, v47, v175
    v_add_f32 v48, v48, v176
    v_add_f32 v49, v49, v177
    v_add_f32 v50, v50, v178
    v_add_f32 v51, v51, v179
    v_add_f32 v52, v52, v180
    v_add_f32 v53, v53, v181
    v_add_f32 v54, v54, v182
    v_add_f32 v55, v55, v183
    v_mul_u32_u24 v12, 1280, v12
    v_lshrrev_b32 v13, 4, v1
    v_lshlrev_b32 v13, 3, v13
    v_add_u32 v12, v12, v13
    s_mov_b32 s45, 0xffff0000
    s_waitcnt vmcnt(0)
    v_sub_f32 v14, 1.0, v15
    v_cvt_pk_bf16_f32 v14, v14, v14
    v_lshlrev_b32 v14, 16, v14
    v_cvt_pk_bf16_f32 v56, v16, v17
    v_cvt_pk_bf16_f32 v57, v36, v37
    v_lshlrev_b32 v58, 16, v56
    v_and_b32 v59, s45, v56
    v_lshlrev_b32 v60, 16, v57
    v_and_b32 v61, s45, v57
    v_mul_f32 v58, v15, v58
    v_mul_f32 v59, v15, v59
    v_mul_f32 v60, v14, v60
    v_mul_f32 v61, v14, v61
    v_cvt_pk_bf16_f32 v56, v58, v59
    v_cvt_pk_bf16_f32 v57, v60, v61
    v_lshlrev_b32 v58, 16, v56
    v_and_b32 v59, s45, v56
    v_lshlrev_b32 v60, 16, v57
    v_and_b32 v61, s45, v57
    v_add_f32 v58, v58, v60
    v_add_f32 v59, v59, v61
    v_cvt_pk_bf16_f32 v62, v58, v59
    v_cvt_pk_bf16_f32 v56, v18, v19
    v_cvt_pk_bf16_f32 v57, v38, v39
    v_lshlrev_b32 v58, 16, v56
    v_and_b32 v59, s45, v56
    v_lshlrev_b32 v60, 16, v57
    v_and_b32 v61, s45, v57
    v_mul_f32 v58, v15, v58
    v_mul_f32 v59, v15, v59
    v_mul_f32 v60, v14, v60
    v_mul_f32 v61, v14, v61
    v_cvt_pk_bf16_f32 v56, v58, v59
    v_cvt_pk_bf16_f32 v57, v60, v61
    v_lshlrev_b32 v58, 16, v56
    v_and_b32 v59, s45, v56
    v_lshlrev_b32 v60, 16, v57
    v_and_b32 v61, s45, v57
    v_add_f32 v58, v58, v60
    v_add_f32 v59, v59, v61
    v_cvt_pk_bf16_f32 v63, v58, v59
    buffer_store_dwordx2 v[62:63], v12, s[36:39], s31 offen offset:0
    s_nop 1
    v_cvt_pk_bf16_f32 v56, v20, v21
    v_cvt_pk_bf16_f32 v57, v40, v41
    v_lshlrev_b32 v58, 16, v56
    v_and_b32 v59, s45, v56
    v_lshlrev_b32 v60, 16, v57
    v_and_b32 v61, s45, v57
    v_mul_f32 v58, v15, v58
    v_mul_f32 v59, v15, v59
    v_mul_f32 v60, v14, v60
    v_mul_f32 v61, v14, v61
    v_cvt_pk_bf16_f32 v56, v58, v59
    v_cvt_pk_bf16_f32 v57, v60, v61
    v_lshlrev_b32 v58, 16, v56
    v_and_b32 v59, s45, v56
    v_lshlrev_b32 v60, 16, v57
    v_and_b32 v61, s45, v57
    v_add_f32 v58, v58, v60
    v_add_f32 v59, v59, v61
    v_cvt_pk_bf16_f32 v62, v58, v59
    v_cvt_pk_bf16_f32 v56, v22, v23
    v_cvt_pk_bf16_f32 v57, v42, v43
    v_lshlrev_b32 v58, 16, v56
    v_and_b32 v59, s45, v56
    v_lshlrev_b32 v60, 16, v57
    v_and_b32 v61, s45, v57
    v_mul_f32 v58, v15, v58
    v_mul_f32 v59, v15, v59
    v_mul_f32 v60, v14, v60
    v_mul_f32 v61, v14, v61
    v_cvt_pk_bf16_f32 v56, v58, v59
    v_cvt_pk_bf16_f32 v57, v60, v61
    v_lshlrev_b32 v58, 16, v56
    v_and_b32 v59, s45, v56
    v_lshlrev_b32 v60, 16, v57
    v_and_b32 v61, s45, v57
    v_add_f32 v58, v58, v60
    v_add_f32 v59, v59, v61
    v_cvt_pk_bf16_f32 v63, v58, v59
    buffer_store_dwordx2 v[62:63], v12, s[36:39], s31 offen offset:32
    s_nop 1
    v_cvt_pk_bf16_f32 v56, v24, v25
    v_cvt_pk_bf16_f32 v57, v44, v45
    v_lshlrev_b32 v58, 16, v56
    v_and_b32 v59, s45, v56
    v_lshlrev_b32 v60, 16, v57
    v_and_b32 v61, s45, v57
    v_mul_f32 v58, v15, v58
    v_mul_f32 v59, v15, v59
    v_mul_f32 v60, v14, v60
    v_mul_f32 v61, v14, v61
    v_cvt_pk_bf16_f32 v56, v58, v59
    v_cvt_pk_bf16_f32 v57, v60, v61
    v_lshlrev_b32 v58, 16, v56
    v_and_b32 v59, s45, v56
    v_lshlrev_b32 v60, 16, v57
    v_and_b32 v61, s45, v57
    v_add_f32 v58, v58, v60
    v_add_f32 v59, v59, v61
    v_cvt_pk_bf16_f32 v62, v58, v59
    v_cvt_pk_bf16_f32 v56, v26, v27
    v_cvt_pk_bf16_f32 v57, v46, v47
    v_lshlrev_b32 v58, 16, v56
    v_and_b32 v59, s45, v56
    v_lshlrev_b32 v60, 16, v57
    v_and_b32 v61, s45, v57
    v_mul_f32 v58, v15, v58
    v_mul_f32 v59, v15, v59
    v_mul_f32 v60, v14, v60
    v_mul_f32 v61, v14, v61
    v_cvt_pk_bf16_f32 v56, v58, v59
    v_cvt_pk_bf16_f32 v57, v60, v61
    v_lshlrev_b32 v58, 16, v56
    v_and_b32 v59, s45, v56
    v_lshlrev_b32 v60, 16, v57
    v_and_b32 v61, s45, v57
    v_add_f32 v58, v58, v60
    v_add_f32 v59, v59, v61
    v_cvt_pk_bf16_f32 v63, v58, v59
    buffer_store_dwordx2 v[62:63], v12, s[36:39], s31 offen offset:64
    s_nop 1
    v_cvt_pk_bf16_f32 v56, v28, v29
    v_cvt_pk_bf16_f32 v57, v48, v49
    v_lshlrev_b32 v58, 16, v56
    v_and_b32 v59, s45, v56
    v_lshlrev_b32 v60, 16, v57
    v_and_b32 v61, s45, v57
    v_mul_f32 v58, v15, v58
    v_mul_f32 v59, v15, v59
    v_mul_f32 v60, v14, v60
    v_mul_f32 v61, v14, v61
    v_cvt_pk_bf16_f32 v56, v58, v59
    v_cvt_pk_bf16_f32 v57, v60, v61
    v_lshlrev_b32 v58, 16, v56
    v_and_b32 v59, s45, v56
    v_lshlrev_b32 v60, 16, v57
    v_and_b32 v61, s45, v57
    v_add_f32 v58, v58, v60
    v_add_f32 v59, v59, v61
    v_cvt_pk_bf16_f32 v62, v58, v59
    v_cvt_pk_bf16_f32 v56, v30, v31
    v_cvt_pk_bf16_f32 v57, v50, v51
    v_lshlrev_b32 v58, 16, v56
    v_and_b32 v59, s45, v56
    v_lshlrev_b32 v60, 16, v57
    v_and_b32 v61, s45, v57
    v_mul_f32 v58, v15, v58
    v_mul_f32 v59, v15, v59
    v_mul_f32 v60, v14, v60
    v_mul_f32 v61, v14, v61
    v_cvt_pk_bf16_f32 v56, v58, v59
    v_cvt_pk_bf16_f32 v57, v60, v61
    v_lshlrev_b32 v58, 16, v56
    v_and_b32 v59, s45, v56
    v_lshlrev_b32 v60, 16, v57
    v_and_b32 v61, s45, v57
    v_add_f32 v58, v58, v60
    v_add_f32 v59, v59, v61
    v_cvt_pk_bf16_f32 v63, v58, v59
    buffer_store_dwordx2 v[62:63], v12, s[36:39], s31 offen offset:96
    s_nop 1
    v_cvt_pk_bf16_f32 v56, v32, v33
    v_cvt_pk_bf16_f32 v57, v52, v53
    v_lshlrev_b32 v58, 16, v56
    v_and_b32 v59, s45, v56
    v_lshlrev_b32 v60, 16, v57
    v_and_b32 v61, s45, v57
    v_mul_f32 v58, v15, v58
    v_mul_f32 v59, v15, v59
    v_mul_f32 v60, v14, v60
    v_mul_f32 v61, v14, v61
    v_cvt_pk_bf16_f32 v56, v58, v59
    v_cvt_pk_bf16_f32 v57, v60, v61
    v_lshlrev_b32 v58, 16, v56
    v_and_b32 v59, s45, v56
    v_lshlrev_b32 v60, 16, v57
    v_and_b32 v61, s45, v57
    v_add_f32 v58, v58, v60
    v_add_f32 v59, v59, v61
    v_cvt_pk_bf16_f32 v62, v58, v59
    v_cvt_pk_bf16_f32 v56, v34, v35
    v_cvt_pk_bf16_f32 v57, v54, v55
    v_lshlrev_b32 v58, 16, v56
    v_and_b32 v59, s45, v56
    v_lshlrev_b32 v60, 16, v57
    v_and_b32 v61, s45, v57
    v_mul_f32 v58, v15, v58
    v_mul_f32 v59, v15, v59
    v_mul_f32 v60, v14, v60
    v_mul_f32 v61, v14, v61
    v_cvt_pk_bf16_f32 v56, v58, v59
    v_cvt_pk_bf16_f32 v57, v60, v61
    v_lshlrev_b32 v58, 16, v56
    v_and_b32 v59, s45, v56
    v_lshlrev_b32 v60, 16, v57
    v_and_b32 v61, s45, v57
    v_add_f32 v58, v58, v60
    v_add_f32 v59, v59, v61
    v_cvt_pk_bf16_f32 v63, v58, v59
    buffer_store_dwordx2 v[62:63], v12, s[36:39], s31 offen offset:128
    s_nop 1
k3_kernel_end:
    s_endpgm

.section .rodata,"a"
.p2align 6
.amdhsa_kernel k3_kernel
  .amdhsa_next_free_vgpr 244
  .amdhsa_next_free_sgpr 64
  .amdhsa_accum_offset 244
  .amdhsa_group_segment_fixed_size 0
  .amdhsa_kernarg_size 88
  .amdhsa_user_sgpr_count 2
  .amdhsa_user_sgpr_kernarg_segment_ptr 1
  .amdhsa_system_sgpr_workgroup_id_x 1
.end_amdhsa_kernel
```
